```python
import torch

def _softmax(x, axis=-1):
    return torch.softmax(x, dim=axis)
def _gelu(x):
    return torch.nn.functional.gelu(x, approximate="tanh")
def _silu(x):
    return torch.nn.functional.silu(x)
def _sigmoid(x):
    return torch.sigmoid(x)
def _layernorm(x, axis=-1, eps=1e-5):
    m = x.mean(dim=axis, keepdim=True)
    v = x.var(dim=axis, keepdim=True, unbiased=False)
    return (x - m) / torch.sqrt(v + eps)
def _scatter_add(tgt, idx, src, axis=0):
    return tgt.clone().index_add_(axis, idx, src)
def _segment_sum(src, seg, n):
    out = torch.zeros((n,) + src.shape[1:], dtype=src.dtype)
    return out.index_add_(0, seg, src)
def _pad(x, pw):
    flat = tuple(v for pair in reversed(pw) for v in pair)
    return torch.nn.functional.pad(x, flat)

kernel_name = 'parallel_sum__ssm_conv_s5__dense_activation_mish__prompt'

def setup_inputs():

    _w = (lambda a: (lambda t: t.to(torch.bfloat16) if t.is_floating_point() else t)(torch.as_tensor(a)))
    def _A_setup():
        B, S, D = 1, 2048, 512
        P = D
        Lambda_re = -0.5 * (lambda _x: torch.exp(torch.as_tensor(_x)))((lambda *s: torch.randn(*s, dtype=torch.bfloat16) * 0.2)(P))
        Lambda_im = (lambda *s: torch.randn(*s, dtype=torch.bfloat16) * 0.8)(P) * 1.0
        B_re = (lambda *s: torch.randn(*s, dtype=torch.bfloat16) * 0.2)(P, D) * (D ** -0.5)
        B_im = (lambda *s: torch.randn(*s, dtype=torch.bfloat16) * 0.2)(P, D) * (D ** -0.5)
        C_re = (lambda *s: torch.randn(*s, dtype=torch.bfloat16) * 0.2)(D, P) * (P ** -0.5)
        C_im = (lambda *s: torch.randn(*s, dtype=torch.bfloat16) * 0.2)(D, P) * (P ** -0.5)
        log_dt = (lambda *s: torch.randn(*s, dtype=torch.bfloat16) * 0.2)(P) * 0.3 - 2.0
        Dskip = (lambda *s: torch.randn(*s, dtype=torch.bfloat16) * 0.05)(D)
        return {
            "x": _w((lambda *s: torch.randn(*s, dtype=torch.bfloat16) * 0.05)(B, S, D)),
            "Lambda_re": _w(Lambda_re),
            "Lambda_im": _w(Lambda_im),
            "B_re": _w(B_re),
            "B_im": _w(B_im),
            "C_re": _w(C_re),
            "C_im": _w(C_im),
            "log_dt": _w(log_dt),
            "Dskip": _w(Dskip),
        }
    _A_in = _A_setup()

    def _B_setup():
        B, S, D, F = 1, 2048, 512, 1792
        return {
            "x": _w((lambda *s: torch.randn(*s, dtype=torch.bfloat16) * 0.05)(B, S, D)),
            "w1": _w((lambda *s: torch.randn(*s, dtype=torch.bfloat16) * 0.8)(D, F) * (D ** -0.5)),
            "b1": _w((lambda *s: torch.randn(*s, dtype=torch.bfloat16) * 0.2)(F)),
            "w2": _w((lambda *s: torch.randn(*s, dtype=torch.bfloat16) * 0.2)(F, D) * (F ** -0.5)),
        }
    _B_in = _B_setup()

    return {
        "A_x": _A_in["x"],
        "A_Lambda_re": _A_in["Lambda_re"],
        "A_Lambda_im": _A_in["Lambda_im"],
        "A_B_re": _A_in["B_re"],
        "A_B_im": _A_in["B_im"],
        "A_C_re": _A_in["C_re"],
        "A_C_im": _A_in["C_im"],
        "A_log_dt": _A_in["log_dt"],
        "A_Dskip": _A_in["Dskip"],
        "B_x": _B_in["x"],
        "B_w1": _B_in["w1"],
        "B_b1": _B_in["b1"],
        "B_w2": _B_in["w2"],
    }

def reference(A_x, A_Lambda_re, A_Lambda_im, A_B_re, A_B_im, A_C_re, A_C_im, A_log_dt, A_Dskip, B_x, B_w1, B_b1, B_w2):
    def _A_ref(x, Lambda_re, Lambda_im, B_re, B_im, C_re, C_im, log_dt, Dskip):
        Bsz, L, H = x.shape
        Lam = Lambda_re + 1j * Lambda_im
        Bmat = B_re + 1j * B_im
        Cmat = C_re + 1j * C_im
        dt = torch.exp(log_dt)
        Lam_bar = torch.exp(dt * Lam)
        B_bar = ((Lam_bar - 1.0) / Lam)[:, None] * Bmat
        Bu = torch.einsum("bld,pd->blp", x + 0j, B_bar)
        h = torch.zeros_like(Bu[:, 0, :])
        hs = []
        for t in range(L):
            h = Lam_bar[None, :] * h + Bu[:, t, :]
            hs.append(h)
        hseq = torch.stack(hs, 1)
        y = 2.0 * torch.einsum("blp,dp->bld", hseq, Cmat).real + x * Dskip[None, None, :]
        return y

    def _B_ref(x, w1, b1, w2):
        h = torch.einsum("bsd,df->bsf", x, w1) + b1
        sp = torch.log1p(torch.exp(-torch.abs(h))) + torch.where(h > 0, h, torch.zeros_like(h))
        act = h * torch.tanh(sp)
        return torch.einsum("bsf,fd->bsd", act, w2)

    x = A_x
    xn = _layernorm(x, axis=-1)
    return x + _A_ref(xn, A_Lambda_re, A_Lambda_im, A_B_re, A_B_im, A_C_re, A_C_im, A_log_dt, A_Dskip) + _B_ref(xn, B_w1, B_b1, B_w2)
```

```asm
; @launch grid=(256,1,1) block=(256,1,1) lds=163840
.amdgcn_target "amdgcn-amd-amdhsa--gfx950"
.text
.globl parallel_sum__ssm_conv_s5__dense_activation_mish__prompt_kernel
.p2align 8
.type parallel_sum__ssm_conv_s5__dense_activation_mish__prompt_kernel,@function
parallel_sum__ssm_conv_s5__dense_activation_mish__prompt_kernel:
    s_cmp_ge_u32 s2, 256
    s_cbranch_scc1 L_end
    s_load_dwordx2 s[36:37], s[0:1], 0
    s_getpc_b64 s[68:69]
    v_lshrrev_b32 v1, 6, v0
    v_and_b32 v0, 63, v0
    s_and_b32 s68, s68, 0xffffff80
    v_readfirstlane_b32 s74, v1
    s_mov_b32 s70, L_code_end-parallel_sum__ssm_conv_s5__dense_activation_mish__prompt_kernel
    s_mov_b32 s71, 0x00020000
    s_lshr_b32 s83, s2, 3
    s_lshl_b32 s83, s83, 2
    s_add_u32 s83, s83, s74
    s_lshl_b32 s83, s83, 9
    v_and_b32 v2, 3, v0
    v_lshlrev_b32 v2, 7, v2
    buffer_load_dword v31, v2, s[68:71], s83 offen
    v_lshrrev_b32 v1, 3, v0
    v_lshrrev_b32 v2, 4, v0
    v_xor_b32 v2, v2, v0
    v_and_b32 v2, 7, v2
    v_lshlrev_b32 v2, 4, v2
    v_lshl_add_u32 v16, v1, 10, v2
    v_lshrrev_b32 v3, 5, v0
    v_mul_u32_u24 v3, 12288, v3
    v_add_u32 v12, v16, v3
    v_xor_b32 v13, 64, v12
    v_add_u32 v14, 6144, v12
    v_add_u32 v15, 9216, v13
    v_add_u32 v13, 3072, v13
    s_lshl_b32 s82, s74, 12
    s_and_b32 s22, s2, 3
    s_bfe_u32 s100, s2, 0x20003
    s_lshr_b32 s72, s2, 5
    s_bfe_u32 s83, s2, 0x10002
    s_lshl_b32 s75, s83, 1
    s_lshl_b32 s83, s83, 3
    s_and_b32 s84, s72, 1
    s_or_b32 s72, s72, s83
    s_add_u32 s75, s75, s84
    s_add_u32 s75, s75, s22
    s_lshl_b32 s75, s75, 1
    s_and_b32 s75, s75, 7
    s_lshl_b32 s85, s72, 17
    s_lshl_b32 s83, s74, 15
    s_add_u32 s85, s85, s83
    s_mov_b32 s38, 2097152
    s_mov_b32 s39, 0x00020000
    s_waitcnt lgkmcnt(0)
    s_add_u32 m0, s82, 16384
    s_add_u32 s83, s75, 0
    s_and_b32 s83, s83, 7
    s_lshl_b32 s83, s83, 7
    s_add_u32 s83, s83, s85
    buffer_load_dwordx4 v12, s[36:39], s83 offen offset:0 lds
    buffer_load_dwordx4 v13, s[36:39], s83 offen offset:1024 lds
    buffer_load_dwordx4 v14, s[36:39], s83 offen offset:2048 lds
    buffer_load_dwordx4 v15, s[36:39], s83 offen offset:3072 lds
    s_load_dwordx2 s[60:61], s[0:1], 120
    s_load_dwordx8 s[8:15], s[0:1], 8
    s_load_dwordx4 s[16:19], s[0:1], 56
    s_load_dwordx2 s[20:21], s[0:1], 88
    s_load_dwordx2 s[44:45], s[0:1], 80
    s_load_dwordx2 s[48:49], s[0:1], 40
    s_load_dwordx2 s[52:53], s[0:1], 48
    s_load_dwordx2 s[56:57], s[0:1], 96
    s_load_dwordx2 s[64:65], s[0:1], 104
    s_add_u32 m0, s82, 32768
    s_add_u32 s83, s75, 1
    s_and_b32 s83, s83, 7
    s_lshl_b32 s83, s83, 7
    s_add_u32 s83, s83, s85
    buffer_load_dwordx4 v12, s[36:39], s83 offen offset:0 lds
    buffer_load_dwordx4 v13, s[36:39], s83 offen offset:1024 lds
    buffer_load_dwordx4 v14, s[36:39], s83 offen offset:2048 lds
    buffer_load_dwordx4 v15, s[36:39], s83 offen offset:3072 lds
    s_mov_b32 s42, 524288
    s_mov_b32 s43, 0x00020000
    s_mov_b32 s46, 1835008
    s_mov_b32 s47, 0x00020000
    s_mov_b32 s50, 524288
    s_mov_b32 s51, 0x00020000
    s_mov_b32 s54, 524288
    s_mov_b32 s55, 0x00020000
    s_mov_b32 s58, 1835008
    s_mov_b32 s59, 0x00020000
    s_mov_b32 s62, 20185088
    s_mov_b32 s63, 0x00020000
    s_mov_b32 s66, 4194304
    s_mov_b32 s67, 0x00020000
    v_and_b32 v1, 31, v0
    s_lshl_b32 s73, s22, 2
    s_or_b32 s73, s73, s100
    v_lshrrev_b32 v2, 5, v0
    v_bfe_u32 v3, v0, 1, 3
    v_xor_b32 v2, v2, v3
    v_lshlrev_b32 v2, 4, v2
    v_lshl_add_u32 v4, v1, 7, v2
    v_xor_b32 v5, 32, v4
    v_xor_b32 v6, 64, v4
    v_xor_b32 v7, 0x60, v4
    s_add_u32 s83, s82, 16384
    v_add_u32 v8, s83, v4
    v_add_u32 v9, s83, v5
    v_add_u32 v10, s83, v6
    v_add_u32 v11, s83, v7
    s_mov_b32 s98, 0x3f803f80
    v_mov_b32 v56, 0
    v_mov_b32 v57, 0
    v_mov_b32 v58, 0
    v_mov_b32 v59, 0
    s_lshl_b32 s83, s74, 9
    s_add_u32 s83, s83, 149504
    v_lshl_add_u32 v1, v0, 3, s83
    ds_write_b64 v1, v[56:57]
    s_waitcnt lgkmcnt(0)
    s_load_dword s77, s[60:61], 0
    s_add_u32 m0, s82, 49152
    s_add_u32 s83, s75, 2
    s_and_b32 s83, s83, 7
    s_lshl_b32 s83, s83, 7
    s_add_u32 s83, s83, s85
    buffer_load_dwordx4 v12, s[36:39], s83 offen offset:0 lds
    buffer_load_dwordx4 v13, s[36:39], s83 offen offset:1024 lds
    buffer_load_dwordx4 v14, s[36:39], s83 offen offset:2048 lds
    buffer_load_dwordx4 v15, s[36:39], s83 offen offset:3072 lds
    s_waitcnt lgkmcnt(0)
    s_waitcnt vmcnt(8)
    ds_read_b128 v[128:131], v8 offset:0
    ds_read_b128 v[132:135], v9 offset:0
    ds_read_b128 v[136:139], v10 offset:0
    ds_read_b128 v[140:143], v11 offset:0
    s_add_u32 m0, s82, 65536
    s_add_u32 s83, s75, 3
    s_and_b32 s83, s83, 7
    s_lshl_b32 s83, s83, 7
    s_add_u32 s83, s83, s85
    buffer_load_dwordx4 v12, s[36:39], s83 offen offset:0 lds
    buffer_load_dwordx4 v13, s[36:39], s83 offen offset:1024 lds
    buffer_load_dwordx4 v14, s[36:39], s83 offen offset:2048 lds
    buffer_load_dwordx4 v15, s[36:39], s83 offen offset:3072 lds
    v_and_b32 v1, 31, v0
    s_lshl_b32 s84, s73, 6
    v_lshl_add_u32 v32, v1, 1, s84
    s_and_b32 s99, s74, 1
    s_mul_i32 s101, s22, 7
    s_lshl_b32 s87, s100, 1
    s_add_u32 s24, s87, 1
    s_cmp_eq_u32 s100, 3
    s_cselect_b32 s24, 3, s24
    s_cselect_b32 s97, 64, 0
    s_add_u32 s87, s87, s101
    s_add_u32 s88, s24, s101
    s_lshl_b32 s87, s87, 7
    s_lshl_b32 s88, s88, 7
    s_cmp_ge_u32 s74, 2
    s_cselect_b32 s101, s88, s87
    s_cselect_b32 s84, s97, 0
    s_add_u32 s101, s101, s84
    s_waitcnt lgkmcnt(0)
    v_dot2c_f32_bf16 v56, s98, v128
    v_dot2c_f32_bf16 v58, v128, v128
    v_dot2c_f32_bf16 v57, s98, v129
    v_dot2c_f32_bf16 v59, v129, v129
    v_dot2c_f32_bf16 v56, s98, v130
    v_dot2c_f32_bf16 v58, v130, v130
    v_dot2c_f32_bf16 v57, s98, v131
    v_dot2c_f32_bf16 v59, v131, v131
    v_dot2c_f32_bf16 v56, s98, v132
    v_dot2c_f32_bf16 v58, v132, v132
    v_dot2c_f32_bf16 v57, s98, v133
    v_dot2c_f32_bf16 v59, v133, v133
    v_dot2c_f32_bf16 v56, s98, v134
    v_dot2c_f32_bf16 v58, v134, v134
    v_dot2c_f32_bf16 v57, s98, v135
    v_dot2c_f32_bf16 v59, v135, v135
    v_dot2c_f32_bf16 v56, s98, v136
    v_dot2c_f32_bf16 v58, v136, v136
    v_dot2c_f32_bf16 v57, s98, v137
    v_dot2c_f32_bf16 v59, v137, v137
    v_dot2c_f32_bf16 v56, s98, v138
    v_dot2c_f32_bf16 v58, v138, v138
    v_dot2c_f32_bf16 v57, s98, v139
    v_dot2c_f32_bf16 v59, v139, v139
    v_dot2c_f32_bf16 v56, s98, v140
    v_dot2c_f32_bf16 v58, v140, v140
    v_dot2c_f32_bf16 v57, s98, v141
    v_dot2c_f32_bf16 v59, v141, v141
    v_dot2c_f32_bf16 v56, s98, v142
    v_dot2c_f32_bf16 v58, v142, v142
    v_dot2c_f32_bf16 v57, s98, v143
    v_dot2c_f32_bf16 v59, v143, v143
    s_waitcnt vmcnt(8)
    ds_read_b128 v[144:147], v8 offset:16384
    ds_read_b128 v[148:151], v9 offset:16384
    ds_read_b128 v[152:155], v10 offset:16384
    ds_read_b128 v[156:159], v11 offset:16384
    s_add_u32 m0, s82, 16384
    s_add_u32 s83, s75, 4
    s_and_b32 s83, s83, 7
    s_lshl_b32 s83, s83, 7
    s_add_u32 s83, s83, s85
    buffer_load_dwordx4 v12, s[36:39], s83 offen offset:0 lds
    buffer_load_dwordx4 v13, s[36:39], s83 offen offset:1024 lds
    buffer_load_dwordx4 v14, s[36:39], s83 offen offset:2048 lds
    buffer_load_dwordx4 v15, s[36:39], s83 offen offset:3072 lds
    s_lshl_b32 s84, s99, 6
    s_xor_b32 s101, s101, s84
    v_and_b32 v2, 3, v0
    v_bfe_u32 v3, v0, 2, 2
    v_lshl_add_u32 v2, v3, 3, v2
    v_bfe_u32 v3, v0, 4, 1
    v_lshl_add_u32 v2, v3, 2, v2
    v_lshl_add_u32 v46, v2, 1, s101
    s_cmp_eq_u32 s99, 1
    s_cselect_b32 s40, s14, s12
    s_cselect_b32 s41, s15, s13
    s_mul_i32 s99, s99, 114688
    s_add_u32 s87, s87, s99
    s_add_u32 s88, s88, s99
    s_lshl_b32 s86, s73, 15
    s_lshr_b32 s84, s74, 1
    s_add_u32 s84, s84, s75
    s_and_b32 s78, s84, 7
    s_add_u32 s84, s84, 2
    s_and_b32 s79, s84, 7
    s_add_u32 s84, s84, 2
    s_and_b32 s80, s84, 7
    s_add_u32 s84, s84, 2
    s_and_b32 s81, s84, 7
    s_waitcnt lgkmcnt(0)
    v_dot2c_f32_bf16 v56, s98, v144
    v_dot2c_f32_bf16 v58, v144, v144
    v_dot2c_f32_bf16 v57, s98, v145
    v_dot2c_f32_bf16 v59, v145, v145
    v_dot2c_f32_bf16 v56, s98, v146
    v_dot2c_f32_bf16 v58, v146, v146
    v_dot2c_f32_bf16 v57, s98, v147
    v_dot2c_f32_bf16 v59, v147, v147
    v_dot2c_f32_bf16 v56, s98, v148
    v_dot2c_f32_bf16 v58, v148, v148
    v_dot2c_f32_bf16 v57, s98, v149
    v_dot2c_f32_bf16 v59, v149, v149
    v_dot2c_f32_bf16 v56, s98, v150
    v_dot2c_f32_bf16 v58, v150, v150
    v_dot2c_f32_bf16 v57, s98, v151
    v_dot2c_f32_bf16 v59, v151, v151
    v_dot2c_f32_bf16 v56, s98, v152
    v_dot2c_f32_bf16 v58, v152, v152
    v_dot2c_f32_bf16 v57, s98, v153
    v_dot2c_f32_bf16 v59, v153, v153
    v_dot2c_f32_bf16 v56, s98, v154
    v_dot2c_f32_bf16 v58, v154, v154
    v_dot2c_f32_bf16 v57, s98, v155
    v_dot2c_f32_bf16 v59, v155, v155
    v_dot2c_f32_bf16 v56, s98, v156
    v_dot2c_f32_bf16 v58, v156, v156
    v_dot2c_f32_bf16 v57, s98, v157
    v_dot2c_f32_bf16 v59, v157, v157
    v_dot2c_f32_bf16 v56, s98, v158
    v_dot2c_f32_bf16 v58, v158, v158
    v_dot2c_f32_bf16 v57, s98, v159
    v_dot2c_f32_bf16 v59, v159, v159
    s_waitcnt vmcnt(8)
    ds_read_b128 v[160:163], v8 offset:32768
    ds_read_b128 v[164:167], v9 offset:32768
    ds_read_b128 v[168:171], v10 offset:32768
    ds_read_b128 v[172:175], v11 offset:32768
    s_add_u32 m0, s82, 32768
    s_add_u32 s83, s75, 5
    s_and_b32 s83, s83, 7
    s_lshl_b32 s83, s83, 7
    s_add_u32 s83, s83, s85
    buffer_load_dwordx4 v12, s[36:39], s83 offen offset:0 lds
    buffer_load_dwordx4 v13, s[36:39], s83 offen offset:1024 lds
    buffer_load_dwordx4 v14, s[36:39], s83 offen offset:2048 lds
    buffer_load_dwordx4 v15, s[36:39], s83 offen offset:3072 lds
    v_xor_b32 v17, 64, v16
    v_add_u32 v18, 14336, v16
    v_add_u32 v19, 21504, v17
    v_add_u32 v17, 7168, v17
    v_and_b32 v3, 1, v0
    v_lshlrev_b32 v3, 4, v3
    v_mov_b32 v29, 0x3f80
    v_lshlrev_b32 v3, v3, v29
    v_bfe_i32 v1, v0, 1, 1
    v_and_b32 v49, v1, v3
    v_xor_b32 v48, v49, v3
    v_lshrrev_b32 v2, 3, v0
    v_mul_u32_u24 v2, 3584, v2
    v_bfe_u32 v3, v0, 4, 1
    v_lshlrev_b32 v3, 2, v3
    v_xor_b32 v3, v3, v0
    v_and_b32 v3, 7, v3
    v_lshl_add_u32 v20, v3, 4, v2
    v_add_u32 v21, 27648, v20
    v_add_u32 v22, 55296, v20
    v_add_u32 v23, 82944, v20
    v_and_b32 v96, 31, v0
    v_lshlrev_b32 v97, 3, v96
    v_add_u32 v97, 153600, v97
    v_lshrrev_b32 v1, 5, v0
    s_lshl_b32 s101, s74, 11
    s_add_u32 s101, s101, 155648
    v_lshl_add_u32 v96, v96, 6, s101
    v_bfe_u32 v98, v0, 1, 2
    v_lshlrev_b32 v99, 1, v1
    v_xor_b32 v98, v98, v99
    s_waitcnt lgkmcnt(0)
    v_dot2c_f32_bf16 v56, s98, v160
    v_dot2c_f32_bf16 v58, v160, v160
    v_dot2c_f32_bf16 v57, s98, v161
    v_dot2c_f32_bf16 v59, v161, v161
    v_dot2c_f32_bf16 v56, s98, v162
    v_dot2c_f32_bf16 v58, v162, v162
    v_dot2c_f32_bf16 v57, s98, v163
    v_dot2c_f32_bf16 v59, v163, v163
    v_dot2c_f32_bf16 v56, s98, v164
    v_dot2c_f32_bf16 v58, v164, v164
    v_dot2c_f32_bf16 v57, s98, v165
    v_dot2c_f32_bf16 v59, v165, v165
    v_dot2c_f32_bf16 v56, s98, v166
    v_dot2c_f32_bf16 v58, v166, v166
    v_dot2c_f32_bf16 v57, s98, v167
    v_dot2c_f32_bf16 v59, v167, v167
    v_dot2c_f32_bf16 v56, s98, v168
    v_dot2c_f32_bf16 v58, v168, v168
    v_dot2c_f32_bf16 v57, s98, v169
    v_dot2c_f32_bf16 v59, v169, v169
    v_dot2c_f32_bf16 v56, s98, v170
    v_dot2c_f32_bf16 v58, v170, v170
    v_dot2c_f32_bf16 v57, s98, v171
    v_dot2c_f32_bf16 v59, v171, v171
    v_dot2c_f32_bf16 v56, s98, v172
    v_dot2c_f32_bf16 v58, v172, v172
    v_dot2c_f32_bf16 v57, s98, v173
    v_dot2c_f32_bf16 v59, v173, v173
    v_dot2c_f32_bf16 v56, s98, v174
    v_dot2c_f32_bf16 v58, v174, v174
    v_dot2c_f32_bf16 v57, s98, v175
    v_dot2c_f32_bf16 v59, v175, v175
    s_waitcnt vmcnt(8)
    ds_read_b128 v[176:179], v8 offset:49152
    ds_read_b128 v[180:183], v9 offset:49152
    ds_read_b128 v[184:187], v10 offset:49152
    ds_read_b128 v[188:191], v11 offset:49152
    s_add_u32 m0, s82, 49152
    s_add_u32 s83, s75, 6
    s_and_b32 s83, s83, 7
    s_lshl_b32 s83, s83, 7
    s_add_u32 s83, s83, s85
    buffer_load_dwordx4 v12, s[36:39], s83 offen offset:0 lds
    buffer_load_dwordx4 v13, s[36:39], s83 offen offset:1024 lds
    buffer_load_dwordx4 v14, s[36:39], s83 offen offset:2048 lds
    buffer_load_dwordx4 v15, s[36:39], s83 offen offset:3072 lds
    v_bfe_u32 v99, v0, 3, 1
    v_xor_b32 v98, v98, v99
    v_lshl_add_u32 v96, v98, 4, v96
    v_xor_b32 v99, 16, v96
    v_bfe_u32 v102, v0, 2, 2
    v_lshrrev_b32 v2, 4, v0
    v_lshl_add_u32 v98, v2, 3, v102
    v_lshl_add_u32 v98, v98, 6, s101
    v_and_b32 v2, 1, v0
    v_lshl_add_u32 v98, v2, 5, v98
    v_lshrrev_b32 v2, 1, v0
    v_xor_b32 v2, v2, v0
    v_and_b32 v2, 8, v2
    v_lshl_add_u32 v98, v2, 1, v98
    v_bfe_u32 v2, v0, 1, 1
    v_lshl_add_u32 v98, v2, 3, v98
    v_bfe_u32 v2, v0, 4, 1
    v_lshl_add_u32 v101, v1, 2, v102
    v_lshl_add_u32 v101, v2, 4, v101
    v_lshlrev_b32 v101, 7, v101
    s_and_b32 s101, s22, 1
    v_xor_b32 v2, s101, v2
    v_lshl_add_u32 v101, v2, 6, v101
    v_bfe_u32 v2, v0, 3, 1
    v_lshl_add_u32 v101, v2, 5, v101
    v_and_b32 v2, 3, v0
    v_lshl_add_u32 v101, v2, 3, v101
    v_and_b32 v102, 15, v0
    v_lshrrev_b32 v2, 4, v0
    v_bfe_u32 v100, v0, 1, 3
    v_xor_b32 v2, v2, v100
    v_lshlrev_b32 v2, 4, v2
    v_lshl_add_u32 v102, v102, 7, v2
    s_and_b32 s101, s100, 1
    s_lshl_b32 s101, s101, 6
    v_xor_b32 v102, s101, v102
    s_lshl_b32 s101, s74, 9
    s_add_u32 s84, s101, 149504
    s_add_u32 s101, s101, 153600
    v_lshl_add_u32 v103, v0, 3, s84
    v_lshl_add_u32 v104, v0, 3, s101
    v_accvgpr_write_b32 a58, v96
    v_accvgpr_write_b32 a57, v97
    s_waitcnt lgkmcnt(0)
    v_dot2c_f32_bf16 v56, s98, v176
    v_dot2c_f32_bf16 v58, v176, v176
    v_dot2c_f32_bf16 v57, s98, v177
    v_dot2c_f32_bf16 v59, v177, v177
    v_dot2c_f32_bf16 v56, s98, v178
    v_dot2c_f32_bf16 v58, v178, v178
    v_dot2c_f32_bf16 v57, s98, v179
    v_dot2c_f32_bf16 v59, v179, v179
    v_dot2c_f32_bf16 v56, s98, v180
    v_dot2c_f32_bf16 v58, v180, v180
    v_dot2c_f32_bf16 v57, s98, v181
    v_dot2c_f32_bf16 v59, v181, v181
    v_dot2c_f32_bf16 v56, s98, v182
    v_dot2c_f32_bf16 v58, v182, v182
    v_dot2c_f32_bf16 v57, s98, v183
    v_dot2c_f32_bf16 v59, v183, v183
    v_dot2c_f32_bf16 v56, s98, v184
    v_dot2c_f32_bf16 v58, v184, v184
    v_dot2c_f32_bf16 v57, s98, v185
    v_dot2c_f32_bf16 v59, v185, v185
    v_dot2c_f32_bf16 v56, s98, v186
    v_dot2c_f32_bf16 v58, v186, v186
    v_dot2c_f32_bf16 v57, s98, v187
    v_dot2c_f32_bf16 v59, v187, v187
    v_dot2c_f32_bf16 v56, s98, v188
    v_dot2c_f32_bf16 v58, v188, v188
    v_dot2c_f32_bf16 v57, s98, v189
    v_dot2c_f32_bf16 v59, v189, v189
    v_dot2c_f32_bf16 v56, s98, v190
    v_dot2c_f32_bf16 v58, v190, v190
    v_dot2c_f32_bf16 v57, s98, v191
    v_dot2c_f32_bf16 v59, v191, v191
    s_waitcnt vmcnt(8)
    ds_read_b128 v[192:195], v8 offset:0
    ds_read_b128 v[196:199], v9 offset:0
    ds_read_b128 v[200:203], v10 offset:0
    ds_read_b128 v[204:207], v11 offset:0
    s_add_u32 m0, s82, 65536
    s_add_u32 s83, s75, 7
    s_and_b32 s83, s83, 7
    s_lshl_b32 s83, s83, 7
    s_add_u32 s83, s83, s85
    buffer_load_dwordx4 v12, s[36:39], s83 offen offset:0 lds
    buffer_load_dwordx4 v13, s[36:39], s83 offen offset:1024 lds
    buffer_load_dwordx4 v14, s[36:39], s83 offen offset:2048 lds
    buffer_load_dwordx4 v15, s[36:39], s83 offen offset:3072 lds
    global_load_ushort v34, v32, s[8:9]
    global_load_ushort v33, v32, s[10:11]
    global_load_ushort v32, v32, s[16:17]
    global_load_ushort v46, v46, s[20:21]
    v_accvgpr_write_b32 a60, v98
    v_accvgpr_write_b32 a59, v99
    v_accvgpr_write_b32 a63, v101
    v_accvgpr_write_b32 a247, v102
    v_accvgpr_write_b32 a49, v103
    v_accvgpr_write_b32 a56, v104
    s_mul_i32 s77, s77, 1664525
    s_add_u32 s77, s77, 1013904226
    s_or_b32 s76, s77, 1
    v_bfe_u32 v2, v0, 2, 2
    v_lshrrev_b32 v3, 5, v0
    v_lshl_add_u32 v3, v3, 3, v2
    v_lshlrev_b32 v24, 7, v3
    v_lshrrev_b32 v2, 1, v2
    v_lshl_add_u32 v24, v2, 6, v24
    v_bfe_u32 v2, v0, 4, 1
    v_lshl_add_u32 v24, v2, 5, v24
    v_and_b32 v2, 3, v0
    v_lshl_add_u32 v24, v2, 3, v24
    v_lshlrev_b32 v28, 4, v0
    v_mov_b32 v27, 0x3f317218
    s_cmp_eq_u32 s24, 1
    s_cselect_b32 s25, 3, 1
    s_cmp_eq_u32 s24, 5
    s_cselect_b32 s26, 3, 5
    s_cmp_eq_u32 s100, 1
    s_cselect_b32 s25, 5, s25
    s_cselect_b32 s26, 1, s26
    s_lshl_b32 s31, s97, 9
    s_lshl_b32 s89, s72, 2
    s_add_u32 s89, s89, s74
    s_lshl_b32 s89, s89, 2
    s_add_u32 s89, s89, s22
    s_lshl_b32 s35, s89, 11
    s_add_u32 s35, s35, 19660800
    s_mul_i32 s89, s89, 45056
    s_add_u32 s89, s89, 262144
    s_lshl_b32 s101, s100, 13
    s_add_u32 s90, s89, s101
    s_add_u32 s91, s90, 2048
    s_lshl_b32 s101, s24, 12
    s_add_u32 s93, s89, s101
    s_lshl_b32 s101, s97, 5
    s_add_u32 s92, s93, s101
    s_add_u32 s93, s93, 2048
    s_lshl_b32 s101, s100, 12
    s_add_u32 s94, s89, s101
    s_add_u32 s94, s94, 28672
    s_xor_b32 s101, s74, s22
    s_lshl_b32 s101, s101, 15
    s_lshl_b32 s95, s100, 17
    s_add_u32 s95, s95, s101
    s_lshl_b32 s101, s22, 8
    s_add_u32 s95, s95, s101
    s_lshr_b32 s101, s100, 1
    s_waitcnt lgkmcnt(0)
    v_dot2c_f32_bf16 v56, s98, v192
    v_dot2c_f32_bf16 v58, v192, v192
    v_dot2c_f32_bf16 v57, s98, v193
    v_dot2c_f32_bf16 v59, v193, v193
    v_dot2c_f32_bf16 v56, s98, v194
    v_dot2c_f32_bf16 v58, v194, v194
    v_dot2c_f32_bf16 v57, s98, v195
    v_dot2c_f32_bf16 v59, v195, v195
    v_dot2c_f32_bf16 v56, s98, v196
    v_dot2c_f32_bf16 v58, v196, v196
    v_dot2c_f32_bf16 v57, s98, v197
    v_dot2c_f32_bf16 v59, v197, v197
    v_dot2c_f32_bf16 v56, s98, v198
    v_dot2c_f32_bf16 v58, v198, v198
    v_dot2c_f32_bf16 v57, s98, v199
    v_dot2c_f32_bf16 v59, v199, v199
    v_dot2c_f32_bf16 v56, s98, v200
    v_dot2c_f32_bf16 v58, v200, v200
    v_dot2c_f32_bf16 v57, s98, v201
    v_dot2c_f32_bf16 v59, v201, v201
    v_dot2c_f32_bf16 v56, s98, v202
    v_dot2c_f32_bf16 v58, v202, v202
    v_dot2c_f32_bf16 v57, s98, v203
    v_dot2c_f32_bf16 v59, v203, v203
    v_dot2c_f32_bf16 v56, s98, v204
    v_dot2c_f32_bf16 v58, v204, v204
    v_dot2c_f32_bf16 v57, s98, v205
    v_dot2c_f32_bf16 v59, v205, v205
    v_dot2c_f32_bf16 v56, s98, v206
    v_dot2c_f32_bf16 v58, v206, v206
    v_dot2c_f32_bf16 v57, s98, v207
    v_dot2c_f32_bf16 v59, v207, v207
    s_waitcnt vmcnt(12)
    ds_read_b128 v[208:211], v8 offset:16384
    ds_read_b128 v[212:215], v9 offset:16384
    ds_read_b128 v[216:219], v10 offset:16384
    ds_read_b128 v[220:223], v11 offset:16384
    s_add_u32 m0, s82, 81920
    s_lshl_b32 s83, s78, 7
    s_add_u32 s83, s83, s86
    buffer_load_dwordx4 v16, s[40:43], s83 offen offset:0 lds
    buffer_load_dwordx4 v17, s[40:43], s83 offen offset:1024 lds
    buffer_load_dwordx4 v18, s[40:43], s83 offen offset:2048 lds
    buffer_load_dwordx4 v19, s[40:43], s83 offen offset:3072 lds
    s_lshl_b32 s101, s101, 7
    s_add_u32 s95, s95, s101
    s_mul_i32 s96, s22, 458752
    s_lshr_b32 s101, s74, 1
    s_lshl_b32 s101, s101, 15
    s_add_u32 s96, s96, s101
    s_lshl_b32 s101, s100, 8
    s_add_u32 s96, s96, s101
    s_lshr_b32 s101, s22, 1
    s_xor_b32 s101, s101, s74
    s_and_b32 s101, s101, 1
    s_lshl_b32 s101, s101, 7
    s_add_u32 s96, s96, s101
    s_lshl_b32 s101, s72, 4
    s_add_u32 s101, s101, s100
    s_lshl_b32 s101, s101, 2
    s_add_u32 s101, s101, s74
    s_xor_b32 s99, s22, 0
    s_lshl_b32 s99, s99, 4
    s_add_u32 s99, s99, s101
    s_mul_i32 s99, s99, 7680
    s_add_u32 s27, s99, 11796480
    s_xor_b32 s99, s22, 1
    s_lshl_b32 s99, s99, 4
    s_add_u32 s99, s99, s101
    s_mul_i32 s99, s99, 7680
    s_add_u32 s28, s99, 11796480
    s_xor_b32 s99, s22, 2
    s_lshl_b32 s99, s99, 4
    s_add_u32 s99, s99, s101
    s_mul_i32 s99, s99, 7680
    s_add_u32 s29, s99, 11799040
    s_xor_b32 s99, s22, 3
    s_lshl_b32 s99, s99, 4
    s_add_u32 s99, s99, s101
    s_mul_i32 s99, s99, 7680
    s_add_u32 s30, s99, 11801600
    s_add_u32 s33, s27, 2560
    s_add_u32 s34, s27, 5120
    s_and_b32 s99, s100, 1
    s_sub_u32 s32, 6, s99
    s_and_b32 s84, s72, 7
    s_lshl_b32 s101, s84, 1
    s_add_u32 s101, s101, s74
    s_mul_i32 s101, s101, 28
    s_mul_i32 s99, s22, 448
    s_add_u32 s101, s101, s99
    s_lshl_b32 s101, s101, 2
    s_add_u32 s101, s101, s100
    s_lshl_b32 s99, s100, 3
    s_add_u32 s99, s99, s84
    s_lshl_b32 s99, s99, 6
    s_add_u32 s99, s99, s22
    s_cmp_lt_u32 s74, 2
    s_cselect_b32 s101, s101, s99
    s_cselect_b32 s99, 56, 32
    s_cselect_b32 s68, s56, s48
    s_cselect_b32 s69, s57, s49
    s_cselect_b32 s70, s58, s50
    s_cmp_eq_u32 s74, 3
    s_cselect_b32 s68, s52, s68
    s_cselect_b32 s69, s53, s69
    s_lshl_b32 s101, s101, 8
    v_lshrrev_b32 v1, 1, v0
    v_and_b32 v2, 1, v0
    v_lshlrev_b32 v2, 7, v2
    v_lshl_add_u32 v1, v1, 10, v2
    s_waitcnt lgkmcnt(0)
    v_dot2c_f32_bf16 v56, s98, v208
    v_dot2c_f32_bf16 v58, v208, v208
    v_dot2c_f32_bf16 v57, s98, v209
    v_dot2c_f32_bf16 v59, v209, v209
    v_dot2c_f32_bf16 v56, s98, v210
    v_dot2c_f32_bf16 v58, v210, v210
    v_dot2c_f32_bf16 v57, s98, v211
    v_dot2c_f32_bf16 v59, v211, v211
    v_dot2c_f32_bf16 v56, s98, v212
    v_dot2c_f32_bf16 v58, v212, v212
    v_dot2c_f32_bf16 v57, s98, v213
    v_dot2c_f32_bf16 v59, v213, v213
    v_dot2c_f32_bf16 v56, s98, v214
    v_dot2c_f32_bf16 v58, v214, v214
    v_dot2c_f32_bf16 v57, s98, v215
    v_dot2c_f32_bf16 v59, v215, v215
    v_dot2c_f32_bf16 v56, s98, v216
    v_dot2c_f32_bf16 v58, v216, v216
    v_dot2c_f32_bf16 v57, s98, v217
    v_dot2c_f32_bf16 v59, v217, v217
    v_dot2c_f32_bf16 v56, s98, v218
    v_dot2c_f32_bf16 v58, v218, v218
    v_dot2c_f32_bf16 v57, s98, v219
    v_dot2c_f32_bf16 v59, v219, v219
    v_dot2c_f32_bf16 v56, s98, v220
    v_dot2c_f32_bf16 v58, v220, v220
    v_dot2c_f32_bf16 v57, s98, v221
    v_dot2c_f32_bf16 v59, v221, v221
    v_dot2c_f32_bf16 v56, s98, v222
    v_dot2c_f32_bf16 v58, v222, v222
    v_dot2c_f32_bf16 v57, s98, v223
    v_dot2c_f32_bf16 v59, v223, v223
    s_waitcnt vmcnt(12)
    ds_read_b128 v[224:227], v8 offset:32768
    ds_read_b128 v[228:231], v9 offset:32768
    ds_read_b128 v[232:235], v10 offset:32768
    ds_read_b128 v[236:239], v11 offset:32768
    s_add_u32 m0, s82, 98304
    s_lshl_b32 s83, s79, 7
    s_add_u32 s83, s83, s86
    buffer_load_dwordx4 v16, s[40:43], s83 offen offset:0 lds
    buffer_load_dwordx4 v17, s[40:43], s83 offen offset:1024 lds
    buffer_load_dwordx4 v18, s[40:43], s83 offen offset:2048 lds
    buffer_load_dwordx4 v19, s[40:43], s83 offen offset:3072 lds
    v_add_u32 v1, s101, v1
    v_mov_b32 v2, 0x7ff00000
    v_cmp_gt_u32 vcc, s99, v0
    s_nop 1
    v_cndmask_b32 v47, v2, v1, vcc
    s_lshl_b32 s101, s73, 4
    s_add_u32 s101, s101, s72
    s_lshl_b32 s101, s101, 9
    s_add_u32 s101, s101, 65024
    s_cmp_eq_u32 s74, 3
    s_cselect_b32 s101, s101, 0x7ff00000
    v_mov_b32 v72, 0x7ff00000
    v_cmp_gt_u32 vcc, 32, v0
    v_add_u32 v64, s101, v28
    v_lshrrev_b32 v1, 5, v0
    v_cndmask_b32 v64, v64, v72, vcc
    s_lshl_b32 s101, s74, 2
    s_add_u32 s101, s101, s72
    s_sub_u32 s101, s101, 16
    v_lshl_add_u32 v1, v1, 1, s101
    s_lshl_b32 s101, s73, 13
    s_add_u32 s101, s101, 65536
    v_and_b32 v73, 31, v0
    v_lshl_add_u32 v2, v73, 4, s101
    v_lshl_add_u32 v65, v1, 9, v2
    v_cmp_gt_i32 vcc, 0, v1
    v_add_u32 v66, 512, v65
    v_mov_b32 v2, s76
    v_cndmask_b32 v65, v65, v72, vcc
    v_cndmask_b32 v67, v2, 0, vcc
    v_cmp_gt_i32 vcc, -1, v1
    s_lshl_b32 s101, s100, 9
    s_add_u32 s101, s101, s35
    v_cndmask_b32 v66, v66, v72, vcc
    v_cndmask_b32 v68, v2, 0, vcc
    v_lshl_add_u32 v69, v73, 2, s101
    v_and_b32 v1, 3, v0
    v_max_u32 v1, 1, v1
    v_xor_b32 v1, s100, v1
    v_lshl_add_u32 v70, v1, 9, s35
    s_bitcmp1_b32 s100, 0
    s_cselect_b32 s101, 0x7ff00000, 0
    v_add_u32 v71, s101, v28
    v_accvgpr_write_b32 a249, v47
    v_accvgpr_write_b32 a48, v64
    v_accvgpr_write_b32 a50, v65
    v_accvgpr_write_b32 a51, v66
    v_accvgpr_write_b32 a52, v67
    v_accvgpr_write_b32 a53, v68
    v_accvgpr_write_b32 a54, v69
    v_accvgpr_write_b32 a55, v70
    v_accvgpr_write_b32 a62, v71
    v_accvgpr_write_b32 a224, 0
    v_accvgpr_write_b32 a225, 0
    v_accvgpr_write_b32 a226, 0
    v_accvgpr_write_b32 a227, 0
    v_accvgpr_write_b32 a228, 0
    v_accvgpr_write_b32 a229, 0
    v_accvgpr_write_b32 a230, 0
    v_accvgpr_write_b32 a231, 0
    v_accvgpr_write_b32 a232, 0
    v_accvgpr_write_b32 a233, 0
    v_accvgpr_write_b32 a234, 0
    v_accvgpr_write_b32 a235, 0
    v_accvgpr_write_b32 a236, 0
    v_accvgpr_write_b32 a237, 0
    v_accvgpr_write_b32 a238, 0
    v_accvgpr_write_b32 a239, 0
    v_accvgpr_write_b32 a240, 0
    s_waitcnt lgkmcnt(0)
    v_dot2c_f32_bf16 v56, s98, v224
    v_dot2c_f32_bf16 v58, v224, v224
    v_dot2c_f32_bf16 v57, s98, v225
    v_dot2c_f32_bf16 v59, v225, v225
    v_dot2c_f32_bf16 v56, s98, v226
    v_dot2c_f32_bf16 v58, v226, v226
    v_dot2c_f32_bf16 v57, s98, v227
    v_dot2c_f32_bf16 v59, v227, v227
    v_dot2c_f32_bf16 v56, s98, v228
    v_dot2c_f32_bf16 v58, v228, v228
    v_dot2c_f32_bf16 v57, s98, v229
    v_dot2c_f32_bf16 v59, v229, v229
    v_dot2c_f32_bf16 v56, s98, v230
    v_dot2c_f32_bf16 v58, v230, v230
    v_dot2c_f32_bf16 v57, s98, v231
    v_dot2c_f32_bf16 v59, v231, v231
    v_dot2c_f32_bf16 v56, s98, v232
    v_dot2c_f32_bf16 v58, v232, v232
    v_dot2c_f32_bf16 v57, s98, v233
    v_dot2c_f32_bf16 v59, v233, v233
    v_dot2c_f32_bf16 v56, s98, v234
    v_dot2c_f32_bf16 v58, v234, v234
    v_dot2c_f32_bf16 v57, s98, v235
    v_dot2c_f32_bf16 v59, v235, v235
    v_dot2c_f32_bf16 v56, s98, v236
    v_dot2c_f32_bf16 v58, v236, v236
    v_dot2c_f32_bf16 v57, s98, v237
    v_dot2c_f32_bf16 v59, v237, v237
    v_dot2c_f32_bf16 v56, s98, v238
    v_dot2c_f32_bf16 v58, v238, v238
    v_dot2c_f32_bf16 v57, s98, v239
    v_dot2c_f32_bf16 v59, v239, v239
    s_waitcnt vmcnt(12)
    ds_read_b128 v[240:243], v8 offset:49152
    ds_read_b128 v[244:247], v9 offset:49152
    ds_read_b128 v[248:251], v10 offset:49152
    ds_read_b128 v[252:255], v11 offset:49152
    s_add_u32 m0, s82, 114688
    s_lshl_b32 s83, s80, 7
    s_add_u32 s83, s83, s86
    buffer_load_dwordx4 v16, s[40:43], s83 offen offset:0 lds
    buffer_load_dwordx4 v17, s[40:43], s83 offen offset:1024 lds
    buffer_load_dwordx4 v18, s[40:43], s83 offen offset:2048 lds
    buffer_load_dwordx4 v19, s[40:43], s83 offen offset:3072 lds
    s_waitcnt lgkmcnt(3)
    v_dot2c_f32_bf16 v56, s98, v240
    v_dot2c_f32_bf16 v58, v240, v240
    v_dot2c_f32_bf16 v57, s98, v241
    v_dot2c_f32_bf16 v59, v241, v241
    v_dot2c_f32_bf16 v56, s98, v242
    v_dot2c_f32_bf16 v58, v242, v242
    v_dot2c_f32_bf16 v57, s98, v243
    v_dot2c_f32_bf16 v59, v243, v243
    s_waitcnt lgkmcnt(0)
    v_dot2c_f32_bf16 v56, s98, v244
    v_dot2c_f32_bf16 v58, v244, v244
    v_dot2c_f32_bf16 v57, s98, v245
    v_dot2c_f32_bf16 v59, v245, v245
    v_dot2c_f32_bf16 v56, s98, v246
    v_dot2c_f32_bf16 v58, v246, v246
    v_dot2c_f32_bf16 v57, s98, v247
    v_dot2c_f32_bf16 v59, v247, v247
    v_dot2c_f32_bf16 v56, s98, v248
    v_dot2c_f32_bf16 v58, v248, v248
    v_dot2c_f32_bf16 v57, s98, v249
    v_dot2c_f32_bf16 v59, v249, v249
    v_dot2c_f32_bf16 v56, s98, v250
    v_dot2c_f32_bf16 v58, v250, v250
    v_dot2c_f32_bf16 v57, s98, v251
    v_dot2c_f32_bf16 v59, v251, v251
    v_dot2c_f32_bf16 v56, s98, v252
    v_dot2c_f32_bf16 v58, v252, v252
    v_dot2c_f32_bf16 v57, s98, v253
    v_dot2c_f32_bf16 v59, v253, v253
    v_dot2c_f32_bf16 v56, s98, v254
    v_dot2c_f32_bf16 v58, v254, v254
    v_dot2c_f32_bf16 v57, s98, v255
    v_dot2c_f32_bf16 v59, v255, v255
    s_nop 1
    v_add_f32 v56, v56, v57
    v_add_f32 v58, v58, v59
    v_mov_b32 v57, v56
    v_mov_b32 v59, v58
    s_nop 0
    v_permlane32_swap_b32 v57, v56
    v_add_f32 v56, v56, v57
    v_mul_f32 v56, 0xbb000000, v56
    v_cvt_pk_bf16_f32 v1, v56, v56
    v_lshlrev_b32 v112, 16, v1
    v_lshlrev_b32 v113, 16, v1
    v_lshlrev_b32 v114, 16, v1
    v_lshlrev_b32 v115, 16, v1
    s_nop 1
    v_mfma_f32_4x4x4_16b_bf16 v[64:67], v[48:49], v[128:129], v[112:115]
    v_permlane32_swap_b32 v59, v58
    v_sub_f32 v29, 0, v112
    v_mfma_f32_4x4x4_16b_bf16 v[68:71], v[48:49], v[130:131], v[112:115]
    v_mfma_f32_4x4x4_16b_bf16 v[72:75], v[48:49], v[132:133], v[112:115]
    s_nop 0
    v_cvt_pk_bf16_f32 v128, v64, v65
    v_cvt_pk_bf16_f32 v129, v66, v67
    v_mfma_f32_4x4x4_16b_bf16 v[76:79], v[48:49], v[134:135], v[112:115]
    v_cvt_pk_bf16_f32 v130, v68, v69
    v_cvt_pk_bf16_f32 v131, v70, v71
    v_mfma_f32_4x4x4_16b_bf16 v[64:67], v[48:49], v[136:137], v[112:115]
    v_cvt_pk_bf16_f32 v132, v72, v73
    v_cvt_pk_bf16_f32 v133, v74, v75
    v_mfma_f32_4x4x4_16b_bf16 v[68:71], v[48:49], v[138:139], v[112:115]
    v_cvt_pk_bf16_f32 v134, v76, v77
    v_cvt_pk_bf16_f32 v135, v78, v79
    v_mfma_f32_4x4x4_16b_bf16 v[72:75], v[48:49], v[140:141], v[112:115]
    v_cvt_pk_bf16_f32 v136, v64, v65
    v_cvt_pk_bf16_f32 v137, v66, v67
    v_mfma_f32_4x4x4_16b_bf16 v[76:79], v[48:49], v[142:143], v[112:115]
    v_cvt_pk_bf16_f32 v138, v68, v69
    v_cvt_pk_bf16_f32 v139, v70, v71
    v_mfma_f32_4x4x4_16b_bf16 v[64:67], v[48:49], v[144:145], v[112:115]
    v_cvt_pk_bf16_f32 v140, v72, v73
    v_cvt_pk_bf16_f32 v141, v74, v75
    v_mfma_f32_4x4x4_16b_bf16 v[68:71], v[48:49], v[146:147], v[112:115]
    v_cvt_pk_bf16_f32 v142, v76, v77
    v_cvt_pk_bf16_f32 v143, v78, v79
    v_mfma_f32_4x4x4_16b_bf16 v[72:75], v[48:49], v[148:149], v[112:115]
    v_cvt_pk_bf16_f32 v144, v64, v65
    v_cvt_pk_bf16_f32 v145, v66, v67
    v_mfma_f32_4x4x4_16b_bf16 v[76:79], v[48:49], v[150:151], v[112:115]
    v_cvt_pk_bf16_f32 v146, v68, v69
    v_cvt_pk_bf16_f32 v147, v70, v71
    v_mfma_f32_4x4x4_16b_bf16 v[64:67], v[48:49], v[152:153], v[112:115]
    v_cvt_pk_bf16_f32 v148, v72, v73
    v_cvt_pk_bf16_f32 v149, v74, v75
    v_mfma_f32_4x4x4_16b_bf16 v[68:71], v[48:49], v[154:155], v[112:115]
    v_cvt_pk_bf16_f32 v150, v76, v77
    v_cvt_pk_bf16_f32 v151, v78, v79
    v_mfma_f32_4x4x4_16b_bf16 v[72:75], v[48:49], v[156:157], v[112:115]
    v_cvt_pk_bf16_f32 v152, v64, v65
    v_cvt_pk_bf16_f32 v153, v66, v67
    v_mfma_f32_4x4x4_16b_bf16 v[76:79], v[48:49], v[158:159], v[112:115]
    v_cvt_pk_bf16_f32 v154, v68, v69
    v_cvt_pk_bf16_f32 v155, v70, v71
    v_mfma_f32_4x4x4_16b_bf16 v[64:67], v[48:49], v[160:161], v[112:115]
    v_cvt_pk_bf16_f32 v156, v72, v73
    v_cvt_pk_bf16_f32 v157, v74, v75
    v_mfma_f32_4x4x4_16b_bf16 v[68:71], v[48:49], v[162:163], v[112:115]
    v_cvt_pk_bf16_f32 v158, v76, v77
    v_cvt_pk_bf16_f32 v159, v78, v79
    v_mfma_f32_4x4x4_16b_bf16 v[72:75], v[48:49], v[164:165], v[112:115]
    v_cvt_pk_bf16_f32 v160, v64, v65
    v_cvt_pk_bf16_f32 v161, v66, v67
    v_mfma_f32_4x4x4_16b_bf16 v[76:79], v[48:49], v[166:167], v[112:115]
    v_cvt_pk_bf16_f32 v162, v68, v69
    v_cvt_pk_bf16_f32 v163, v70, v71
    v_mfma_f32_4x4x4_16b_bf16 v[64:67], v[48:49], v[168:169], v[112:115]
    v_cvt_pk_bf16_f32 v164, v72, v73
    v_cvt_pk_bf16_f32 v165, v74, v75
    v_mfma_f32_4x4x4_16b_bf16 v[68:71], v[48:49], v[170:171], v[112:115]
    v_cvt_pk_bf16_f32 v166, v76, v77
    v_cvt_pk_bf16_f32 v167, v78, v79
    v_mfma_f32_4x4x4_16b_bf16 v[72:75], v[48:49], v[172:173], v[112:115]
    v_cvt_pk_bf16_f32 v168, v64, v65
    v_cvt_pk_bf16_f32 v169, v66, v67
    v_mfma_f32_4x4x4_16b_bf16 v[76:79], v[48:49], v[174:175], v[112:115]
    v_cvt_pk_bf16_f32 v170, v68, v69
    v_cvt_pk_bf16_f32 v171, v70, v71
    v_mfma_f32_4x4x4_16b_bf16 v[64:67], v[48:49], v[176:177], v[112:115]
    v_cvt_pk_bf16_f32 v172, v72, v73
    v_cvt_pk_bf16_f32 v173, v74, v75
    s_add_u32 m0, s82, 131072
    s_lshl_b32 s83, s81, 7
    s_add_u32 s83, s83, s86
    buffer_load_dwordx4 v16, s[40:43], s83 offen offset:0 lds
    v_mfma_f32_4x4x4_16b_bf16 v[68:71], v[48:49], v[178:179], v[112:115]
    v_cvt_pk_bf16_f32 v174, v76, v77
    v_cvt_pk_bf16_f32 v175, v78, v79
    v_mfma_f32_4x4x4_16b_bf16 v[72:75], v[48:49], v[180:181], v[112:115]
    v_cvt_pk_bf16_f32 v176, v64, v65
    v_cvt_pk_bf16_f32 v177, v66, v67
    v_mfma_f32_4x4x4_16b_bf16 v[76:79], v[48:49], v[182:183], v[112:115]
    v_cvt_pk_bf16_f32 v178, v68, v69
    v_cvt_pk_bf16_f32 v179, v70, v71
    buffer_load_dwordx4 v17, s[40:43], s83 offen offset:1024 lds
    v_mfma_f32_4x4x4_16b_bf16 v[64:67], v[48:49], v[184:185], v[112:115]
    v_cvt_pk_bf16_f32 v180, v72, v73
    v_cvt_pk_bf16_f32 v181, v74, v75
    v_mfma_f32_4x4x4_16b_bf16 v[68:71], v[48:49], v[186:187], v[112:115]
    v_cvt_pk_bf16_f32 v182, v76, v77
    v_cvt_pk_bf16_f32 v183, v78, v79
    v_mfma_f32_4x4x4_16b_bf16 v[72:75], v[48:49], v[188:189], v[112:115]
    v_cvt_pk_bf16_f32 v184, v64, v65
    v_cvt_pk_bf16_f32 v185, v66, v67
    buffer_load_dwordx4 v18, s[40:43], s83 offen offset:2048 lds
    v_mfma_f32_4x4x4_16b_bf16 v[76:79], v[48:49], v[190:191], v[112:115]
    v_cvt_pk_bf16_f32 v186, v68, v69
    v_cvt_pk_bf16_f32 v187, v70, v71
    v_mfma_f32_4x4x4_16b_bf16 v[64:67], v[48:49], v[192:193], v[112:115]
    v_cvt_pk_bf16_f32 v188, v72, v73
    v_cvt_pk_bf16_f32 v189, v74, v75
    v_mfma_f32_4x4x4_16b_bf16 v[68:71], v[48:49], v[194:195], v[112:115]
    v_cvt_pk_bf16_f32 v190, v76, v77
    v_cvt_pk_bf16_f32 v191, v78, v79
    buffer_load_dwordx4 v19, s[40:43], s83 offen offset:3072 lds
    v_mfma_f32_4x4x4_16b_bf16 v[72:75], v[48:49], v[196:197], v[112:115]
    v_cvt_pk_bf16_f32 v192, v64, v65
    v_cvt_pk_bf16_f32 v193, v66, v67
    v_mfma_f32_4x4x4_16b_bf16 v[76:79], v[48:49], v[198:199], v[112:115]
    v_cvt_pk_bf16_f32 v194, v68, v69
    v_cvt_pk_bf16_f32 v195, v70, v71
    v_mfma_f32_4x4x4_16b_bf16 v[64:67], v[48:49], v[200:201], v[112:115]
    v_cvt_pk_bf16_f32 v196, v72, v73
    v_cvt_pk_bf16_f32 v197, v74, v75
    s_add_u32 m0, s82, 0
    s_mul_i32 s83, s78, 229376
    s_add_u32 s83, s83, s87
    buffer_load_dwordx4 v20, s[44:47], s83 offen offset:0 lds
    v_mfma_f32_4x4x4_16b_bf16 v[68:71], v[48:49], v[202:203], v[112:115]
    v_cvt_pk_bf16_f32 v198, v76, v77
    v_cvt_pk_bf16_f32 v199, v78, v79
    v_mfma_f32_4x4x4_16b_bf16 v[72:75], v[48:49], v[204:205], v[112:115]
    v_cvt_pk_bf16_f32 v200, v64, v65
    v_cvt_pk_bf16_f32 v201, v66, v67
    v_mfma_f32_4x4x4_16b_bf16 v[76:79], v[48:49], v[206:207], v[112:115]
    v_cvt_pk_bf16_f32 v202, v68, v69
    v_cvt_pk_bf16_f32 v203, v70, v71
    buffer_load_dwordx4 v21, s[44:47], s83 offen offset:1024 lds
    v_mfma_f32_4x4x4_16b_bf16 v[64:67], v[48:49], v[208:209], v[112:115]
    v_cvt_pk_bf16_f32 v204, v72, v73
    v_cvt_pk_bf16_f32 v205, v74, v75
    v_mfma_f32_4x4x4_16b_bf16 v[68:71], v[48:49], v[210:211], v[112:115]
    v_cvt_pk_bf16_f32 v206, v76, v77
    v_cvt_pk_bf16_f32 v207, v78, v79
    v_mfma_f32_4x4x4_16b_bf16 v[72:75], v[48:49], v[212:213], v[112:115]
    v_cvt_pk_bf16_f32 v208, v64, v65
    v_cvt_pk_bf16_f32 v209, v66, v67
    buffer_load_dwordx4 v22, s[44:47], s83 offen offset:2048 lds
    v_mfma_f32_4x4x4_16b_bf16 v[76:79], v[48:49], v[214:215], v[112:115]
    v_cvt_pk_bf16_f32 v210, v68, v69
    v_cvt_pk_bf16_f32 v211, v70, v71
    v_mfma_f32_4x4x4_16b_bf16 v[64:67], v[48:49], v[216:217], v[112:115]
    v_cvt_pk_bf16_f32 v212, v72, v73
    v_cvt_pk_bf16_f32 v213, v74, v75
    v_mfma_f32_4x4x4_16b_bf16 v[68:71], v[48:49], v[218:219], v[112:115]
    v_cvt_pk_bf16_f32 v214, v76, v77
    v_cvt_pk_bf16_f32 v215, v78, v79
    buffer_load_dwordx4 v23, s[44:47], s83 offen offset:3072 lds
    v_mfma_f32_4x4x4_16b_bf16 v[72:75], v[48:49], v[220:221], v[112:115]
    v_cvt_pk_bf16_f32 v216, v64, v65
    v_cvt_pk_bf16_f32 v217, v66, v67
    v_mfma_f32_4x4x4_16b_bf16 v[76:79], v[48:49], v[222:223], v[112:115]
    v_cvt_pk_bf16_f32 v218, v68, v69
    v_cvt_pk_bf16_f32 v219, v70, v71
    v_mfma_f32_4x4x4_16b_bf16 v[64:67], v[48:49], v[224:225], v[112:115]
    v_cvt_pk_bf16_f32 v220, v72, v73
    v_cvt_pk_bf16_f32 v221, v74, v75
    v_mfma_f32_4x4x4_16b_bf16 v[68:71], v[48:49], v[226:227], v[112:115]
    v_cvt_pk_bf16_f32 v222, v76, v77
    v_cvt_pk_bf16_f32 v223, v78, v79
    v_mfma_f32_4x4x4_16b_bf16 v[72:75], v[48:49], v[228:229], v[112:115]
    v_cvt_pk_bf16_f32 v224, v64, v65
    v_cvt_pk_bf16_f32 v225, v66, v67
    v_mfma_f32_4x4x4_16b_bf16 v[76:79], v[48:49], v[230:231], v[112:115]
    v_cvt_pk_bf16_f32 v226, v68, v69
    v_cvt_pk_bf16_f32 v227, v70, v71
    v_mfma_f32_4x4x4_16b_bf16 v[64:67], v[48:49], v[232:233], v[112:115]
    v_cvt_pk_bf16_f32 v228, v72, v73
    v_cvt_pk_bf16_f32 v229, v74, v75
    v_mfma_f32_4x4x4_16b_bf16 v[68:71], v[48:49], v[234:235], v[112:115]
    v_cvt_pk_bf16_f32 v230, v76, v77
    v_cvt_pk_bf16_f32 v231, v78, v79
    v_mfma_f32_4x4x4_16b_bf16 v[72:75], v[48:49], v[236:237], v[112:115]
    v_cvt_pk_bf16_f32 v232, v64, v65
    v_cvt_pk_bf16_f32 v233, v66, v67
    v_add_u32 v8, 81920, v4
    v_add_u32 v9, 81920, v5
    v_add_u32 v10, 81920, v6
    v_add_u32 v11, 81920, v7
    s_waitcnt vmcnt(16)
    s_barrier
    v_mfma_f32_4x4x4_16b_bf16 v[76:79], v[48:49], v[238:239], v[112:115]
    v_cvt_pk_bf16_f32 v234, v68, v69
    v_cvt_pk_bf16_f32 v235, v70, v71
    ds_read_b128 a[0:3], v8 offset:0
    ds_read_b128 a[4:7], v8 offset:4096
    v_mfma_f32_4x4x4_16b_bf16 v[64:67], v[48:49], v[240:241], v[112:115]
    v_cvt_pk_bf16_f32 v236, v72, v73
    v_cvt_pk_bf16_f32 v237, v74, v75
    v_mfma_f32_4x4x4_16b_bf16 v[68:71], v[48:49], v[242:243], v[112:115]
    v_cvt_pk_bf16_f32 v238, v76, v77
    v_cvt_pk_bf16_f32 v239, v78, v79
    ds_read_b128 a[8:11], v9 offset:0
    ds_read_b128 a[12:15], v9 offset:4096
    v_mfma_f32_4x4x4_16b_bf16 v[72:75], v[48:49], v[244:245], v[112:115]
    v_cvt_pk_bf16_f32 v240, v64, v65
    v_cvt_pk_bf16_f32 v241, v66, v67
    v_mfma_f32_4x4x4_16b_bf16 v[76:79], v[48:49], v[246:247], v[112:115]
    v_cvt_pk_bf16_f32 v242, v68, v69
    v_cvt_pk_bf16_f32 v243, v70, v71
    ds_read_b128 a[16:19], v10 offset:0
    ds_read_b128 a[20:23], v10 offset:4096
    v_mfma_f32_4x4x4_16b_bf16 v[64:67], v[48:49], v[248:249], v[112:115]
    v_cvt_pk_bf16_f32 v244, v72, v73
    v_cvt_pk_bf16_f32 v245, v74, v75
    v_mfma_f32_4x4x4_16b_bf16 v[68:71], v[48:49], v[250:251], v[112:115]
    v_cvt_pk_bf16_f32 v246, v76, v77
    v_cvt_pk_bf16_f32 v247, v78, v79
    v_mfma_f32_4x4x4_16b_bf16 v[72:75], v[48:49], v[252:253], v[112:115]
    v_cvt_pk_bf16_f32 v248, v64, v65
    v_cvt_pk_bf16_f32 v249, v66, v67
    v_mfma_f32_4x4x4_16b_bf16 v[76:79], v[48:49], v[254:255], v[112:115]
    v_cvt_pk_bf16_f32 v250, v68, v69
    v_cvt_pk_bf16_f32 v251, v70, v71
    v_cvt_pk_bf16_f32 v252, v72, v73
    v_cvt_pk_bf16_f32 v253, v74, v75
    s_nop 0
    v_cvt_pk_bf16_f32 v254, v76, v77
    v_cvt_pk_bf16_f32 v255, v78, v79
    s_waitcnt lgkmcnt(0)
    v_mfma_f32_32x32x16_bf16 v[96:111], v[128:131], a[0:3], 0
    ds_read_b128 a[24:27], v11 offset:0
    v_add_f32 v58, v58, v59
    v_and_b32 v62, 31, v0
    v_mul_f32 v58, 0x3b000000, v58
    v_fma_f32 v58, -v56, v56, v58
    v_mfma_f32_32x32x16_bf16 v[112:127], v[128:131], a[4:7], 0
    ds_read_b128 a[28:31], v11 offset:4096
    v_max_f32 v58, 0, v58
    v_cvt_pk_bf16_f32 v1, v58, v58
    v_lshlrev_b32 v1, 16, v1
    v_lshrrev_b32 v63, 5, v0
    v_mfma_f32_32x32x16_bf16 v[96:111], v[132:135], a[8:11], v[96:111]
    ds_read_b128 a[0:3], v8 offset:8192
    s_add_u32 m0, s82, 16384
    s_mul_i32 s83, s79, 229376
    s_add_u32 s83, s83, s87
    buffer_load_dwordx4 v20, s[44:47], s83 offen offset:0 lds
    v_mfma_f32_32x32x16_bf16 v[112:127], v[132:135], a[12:15], v[112:127]
    ds_read_b128 a[4:7], v8 offset:12288
    v_add_f32 v1, 0x3727c5ac, v1
    v_cvt_pk_bf16_f32 v1, v1, v1
    v_lshlrev_b32 v1, 16, v1
    v_mfma_f32_32x32x16_bf16 v[96:111], v[136:139], a[16:19], v[96:111]
    ds_read_b128 a[8:11], v9 offset:8192
    v_sqrt_f32 v1, v1
    v_and_b32 v2, 3, v0
    v_lshlrev_b32 v63, 12, v63
    v_cvt_pk_bf16_f32 v1, v1, v1
    v_mfma_f32_32x32x16_bf16 v[112:127], v[136:139], a[20:23], v[112:127]
    ds_read_b128 a[12:15], v9 offset:12288
    buffer_load_dwordx4 v21, s[44:47], s83 offen offset:1024 lds
    v_lshlrev_b32 v1, 16, v1
    v_rcp_f32 v30, v1
    s_waitcnt lgkmcnt(2)
    v_mfma_f32_32x32x16_bf16 v[96:111], v[140:143], a[24:27], v[96:111]
    ds_read_b128 a[16:19], v10 offset:8192
    v_bfe_u32 v3, v0, 3, 2
    v_lshl_add_u32 v63, v62, 1, v63
    v_lshl_add_u32 v2, v3, 2, v2
    v_bfe_u32 v3, v0, 2, 1
    v_mfma_f32_32x32x16_bf16 v[112:127], v[140:143], a[28:31], v[112:127]
    ds_read_b128 a[20:23], v10 offset:12288
    v_lshl_add_u32 v2, v3, 4, v2
    s_lshl_b32 s84, s74, 8
    s_add_u32 s84, s84, 147456
    v_lshl_add_u32 v2, v2, 2, s84
    v_mfma_f32_32x32x16_bf16 v[96:111], v[144:147], a[0:3], v[96:111]
    ds_read_b128 a[24:27], v11 offset:8192
    buffer_load_dwordx4 v22, s[44:47], s83 offen offset:2048 lds
    s_lshl_b32 s98, s100, 2
    v_mul_f32 v26, 0x3fb8aa3b, v30
    ds_write_b32 v2, v29
    v_mfma_f32_32x32x16_bf16 v[112:127], v[144:147], a[4:7], v[112:127]
    ds_read_b128 a[28:31], v11 offset:12288
    s_waitcnt vmcnt(15)
    s_barrier
    ds_write_b32 v2, v30 offset:128
    v_lshlrev_b32 v32, 16, v32
    s_waitcnt lgkmcnt(4)
    v_mfma_f32_32x32x16_bf16 v[96:111], v[148:151], a[8:11], v[96:111]
    ds_read_b128 a[0:3], v8 offset:16384
    v_mul_f32 v32, 0x3fb8aa3b, v32
    s_add_u32 s98, s98, s22
    v_exp_f32 v32, v32
    v_mfma_f32_32x32x16_bf16 v[112:127], v[148:151], a[12:15], v[112:127]
    ds_read_b128 a[4:7], v8 offset:20480
    buffer_load_dwordx4 v23, s[44:47], s83 offen offset:3072 lds
    v_lshlrev_b32 v52, 16, v34
    v_lshlrev_b32 v53, 16, v33
    v_cvt_pk_bf16_f32 v32, v32, v32
    v_mfma_f32_32x32x16_bf16 v[96:111], v[152:155], a[16:19], v[96:111]
    ds_read_b128 a[8:11], v9 offset:16384
    v_lshlrev_b32 v32, 16, v32
    s_lshl_b32 s98, s98, 6
    v_mul_f32 v50, v32, v52
    v_mul_f32 v51, v32, v53
    v_mfma_f32_32x32x16_bf16 v[112:127], v[152:155], a[20:23], v[112:127]
    ds_read_b128 a[12:15], v9 offset:20480
    v_mul_f32 v50, 0x3fb8aa3b, v50
    v_mul_f32 v51, 0xbe22f983, v51
    v_mul_f32 v34, 1.0, v50
    v_lshl_add_u32 v62, v62, 1, s98
    s_waitcnt lgkmcnt(2)
    v_mfma_f32_32x32x16_bf16 v[96:111], v[156:159], a[24:27], v[96:111]
    ds_read_b128 a[16:19], v10 offset:16384
    s_add_u32 m0, s82, 32768
    s_mul_i32 s83, s80, 229376
    s_add_u32 s83, s83, s87
    buffer_load_dwordx4 v20, s[44:47], s83 offen offset:0 lds
    v_mfma_f32_32x32x16_bf16 v[112:127], v[156:159], a[28:31], v[112:127]
    ds_read_b128 a[20:23], v10 offset:20480
    v_mul_f32 v33, 1.0, v51
    v_exp_f32 v34, v34
    v_mfma_f32_32x32x16_bf16 v[96:111], v[160:163], a[0:3], v[96:111]
    ds_read_b128 a[24:27], v11 offset:16384
    v_fract_f32 v33, v33
    v_cos_f32 v31, v33
    s_add_u32 s85, s85, s98
    v_mfma_f32_32x32x16_bf16 v[112:127], v[160:163], a[4:7], v[112:127]
    ds_read_b128 a[28:31], v11 offset:20480
    buffer_load_dwordx4 v21, s[44:47], s83 offen offset:1024 lds
    v_sin_f32 v33, v33
    s_nop 0
    v_mul_f32 v33, v34, v33
    s_waitcnt lgkmcnt(2)
    v_mfma_f32_32x32x16_bf16 v[96:111], v[164:167], a[8:11], v[96:111]
    ds_read_b128 a[0:3], v8 offset:24576
    v_mul_f32 v34, v34, v31
    v_mul_f32 v54, v52, v52
    global_load_short_d16_hi a240, v62, s[18:19]
    v_fmac_f32 v54, v53, v53
    v_mfma_f32_32x32x16_bf16 v[112:127], v[164:167], a[12:15], v[112:127]
    ds_read_b128 a[4:7], v8 offset:28672
    v_rcp_f32 v54, v54
    v_add_f32 v55, -1.0, v34
    v_sub_f32 v32, 0, v33
    v_mfma_f32_32x32x16_bf16 v[96:111], v[168:171], a[16:19], v[96:111]
    ds_read_b128 a[8:11], v9 offset:24576
    buffer_load_dwordx4 v22, s[44:47], s83 offen offset:2048 lds
    v_add_f32 v54, v54, v54
    s_add_u32 s98, s85, 0
    v_mul_f32 v35, v55, v52
    v_mfma_f32_32x32x16_bf16 v[112:127], v[168:171], a[20:23], v[112:127]
    ds_read_b128 a[12:15], v9 offset:28672
    v_fmac_f32 v35, v32, v53
    v_mul_f32 v36, v55, v53
    v_fmac_f32 v36, v33, v52
    v_mul_f32 v35, v35, v54
    s_waitcnt lgkmcnt(2)
    v_mfma_f32_32x32x16_bf16 v[96:111], v[172:175], a[24:27], v[96:111]
    ds_read_b128 a[16:19], v10 offset:24576
    buffer_load_short_d16_hi a224, v63, s[36:39], s98 offen offset:0
    v_mul_f32 v36, v36, v54
    v_sub_f32 v37, 0, v35
    v_mul_f32 v38, 0x41800000, v50
    v_mfma_f32_32x32x16_bf16 v[112:127], v[172:175], a[28:31], v[112:127]
    ds_read_b128 a[20:23], v10 offset:28672
    buffer_load_dwordx4 v23, s[44:47], s83 offen offset:3072 lds
    v_mul_f32 v39, 0x41800000, v51
    v_exp_f32 v38, v38
    v_mfma_f32_32x32x16_bf16 v[96:111], v[176:179], a[0:3], v[96:111]
    ds_read_b128 a[24:27], v11 offset:24576
    buffer_load_short_d16_hi a225, v63, s[36:39], s98 offen offset:1024
    v_fract_f32 v39, v39
    v_cos_f32 v31, v39
    v_mfma_f32_32x32x16_bf16 v[112:127], v[176:179], a[4:7], v[112:127]
    ds_read_b128 a[28:31], v11 offset:28672
    s_waitcnt vmcnt(19)
    s_barrier
    v_sin_f32 v39, v39
    s_waitcnt lgkmcnt(2)
    v_mfma_f32_32x32x16_bf16 v[96:111], v[180:183], a[8:11], v[96:111]
    ds_read_b128 a[0:3], v8 offset:32768
    buffer_load_short_d16_hi a226, v63, s[36:39], s98 offen offset:2048
    v_mul_f32 v39, v38, v39
    v_mul_f32 v38, v38, v31
    v_mul_f32 v42, 0x43000000, v50
    v_mfma_f32_32x32x16_bf16 v[112:127], v[180:183], a[12:15], v[112:127]
    ds_read_b128 a[4:7], v8 offset:36864
    v_mul_f32 v43, 0x43000000, v51
    v_exp_f32 v42, v42
    buffer_load_short_d16_hi a227, v63, s[36:39], s98 offen offset:3072
    v_mfma_f32_32x32x16_bf16 v[96:111], v[184:187], a[16:19], v[96:111]
    ds_read_b128 a[8:11], v9 offset:32768
    s_add_u32 m0, s82, 49152
    s_mul_i32 s83, s81, 229376
    s_add_u32 s83, s83, s87
    buffer_load_dwordx4 v20, s[44:47], s83 offen offset:0 lds
    v_mfma_f32_32x32x16_bf16 v[112:127], v[184:187], a[20:23], v[112:127]
    ds_read_b128 a[12:15], v9 offset:36864
    v_fract_f32 v43, v43
    v_cos_f32 v31, v43
    s_waitcnt lgkmcnt(2)
    v_mfma_f32_32x32x16_bf16 v[96:111], v[188:191], a[24:27], v[96:111]
    ds_read_b128 a[16:19], v10 offset:32768
    v_sin_f32 v43, v43
    s_nop 0
    v_mul_f32 v43, v42, v43
    s_add_u32 s98, s85, 16384
    v_mul_f32 v42, v42, v31
    v_mfma_f32_32x32x16_bf16 v[112:127], v[188:191], a[28:31], v[112:127]
    ds_read_b128 a[20:23], v10 offset:36864
    buffer_load_dwordx4 v21, s[44:47], s83 offen offset:1024 lds
    v_lshrrev_b32 v56, 5, v0
    s_lshl_b32 s101, s74, 1
    v_add_u32 v56, s101, v56
    v_mfma_f32_32x32x16_bf16 v[96:111], v[192:195], a[0:3], v[96:111]
    ds_read_b128 a[24:27], v11 offset:32768
    v_cvt_f32_u32 v56, v56
    buffer_load_short_d16_hi a228, v63, s[36:39], s98 offen offset:0
    v_mul_f32 v57, 0x41800000, v56
    v_sub_f32 v56, 0x40e00000, v56
    v_mfma_f32_32x32x16_bf16 v[112:127], v[192:195], a[4:7], v[112:127]
    ds_read_b128 a[28:31], v11 offset:36864
    v_mul_f32 v56, 0x43800000, v56
    v_mul_f32 v40, v57, v50
    v_mul_f32 v41, v57, v51
    s_waitcnt lgkmcnt(2)
    v_mfma_f32_32x32x16_bf16 v[96:111], v[196:199], a[8:11], v[96:111]
    ds_read_b128 a[0:3], v8 offset:40960
    buffer_load_dwordx4 v22, s[44:47], s83 offen offset:2048 lds
    v_exp_f32 v40, v40
    buffer_load_short_d16_hi a229, v63, s[36:39], s98 offen offset:1024
    v_fract_f32 v41, v41
    v_mfma_f32_32x32x16_bf16 v[112:127], v[196:199], a[12:15], v[112:127]
    ds_read_b128 a[4:7], v8 offset:45056
    v_cos_f32 v31, v41
    v_sin_f32 v41, v41
    v_mfma_f32_32x32x16_bf16 v[96:111], v[200:203], a[16:19], v[96:111]
    ds_read_b128 a[8:11], v9 offset:40960
    buffer_load_short_d16_hi a230, v63, s[36:39], s98 offen offset:2048
    v_mul_f32 v41, v40, v41
    v_mul_f32 v40, v40, v31
    v_mul_f32 v44, v56, v50
    v_mfma_f32_32x32x16_bf16 v[112:127], v[200:203], a[20:23], v[112:127]
    ds_read_b128 a[12:15], v9 offset:45056
    buffer_load_dwordx4 v23, s[44:47], s83 offen offset:3072 lds
    v_mul_f32 v45, v56, v51
    v_exp_f32 v44, v44
    s_waitcnt lgkmcnt(2)
    v_mfma_f32_32x32x16_bf16 v[96:111], v[204:207], a[24:27], v[96:111]
    ds_read_b128 a[16:19], v10 offset:40960
    buffer_load_short_d16_hi a231, v63, s[36:39], s98 offen offset:3072
    v_fract_f32 v45, v45
    v_cos_f32 v31, v45
    v_mfma_f32_32x32x16_bf16 v[112:127], v[204:207], a[28:31], v[112:127]
    ds_read_b128 a[20:23], v10 offset:45056
    v_sin_f32 v45, v45
    s_add_u32 s98, s85, 8192
    v_mul_f32 v45, v44, v45
    v_mfma_f32_32x32x16_bf16 v[96:111], v[208:211], a[0:3], v[96:111]
    ds_read_b128 a[24:27], v11 offset:40960
    v_mul_f32 v44, v44, v31
    v_lshlrev_b32 v46, 16, v46
    v_mul_f32 v46, 0x3fb8aa3b, v46
    v_and_b32 v2, 31, v0
    v_mfma_f32_32x32x16_bf16 v[112:127], v[208:211], a[4:7], v[112:127]
    ds_read_b128 a[28:31], v11 offset:45056
    s_waitcnt vmcnt(25)
    s_barrier
    buffer_load_short_d16_hi a232, v63, s[36:39], s98 offen offset:0
    s_lshl_b32 s84, s74, 7
    s_waitcnt lgkmcnt(2)
    v_mfma_f32_32x32x16_bf16 v[96:111], v[212:215], a[8:11], v[96:111]
    ds_read_b128 a[0:3], v8 offset:49152
    s_add_u32 m0, s82, 65536
    s_mul_i32 s83, s78, 229376
    s_add_u32 s83, s83, s88
    buffer_load_dwordx4 v20, s[44:47], s83 offen offset:0 lds
    v_mfma_f32_32x32x16_bf16 v[112:127], v[212:215], a[12:15], v[112:127]
    ds_read_b128 a[4:7], v8 offset:53248
    s_add_u32 s84, s84, 148480
    v_lshl_add_u32 v2, v2, 2, s84
    ds_write_b32 v2, v46
    v_mfma_f32_32x32x16_bf16 v[96:111], v[216:219], a[16:19], v[96:111]
    ds_read_b128 a[8:11], v9 offset:49152
    v_lshrrev_b32 v1, 3, v0
    buffer_load_short_d16_hi a233, v63, s[36:39], s98 offen offset:1024
    v_bfe_u32 v2, v0, 4, 1
    v_lshlrev_b32 v2, 1, v2
    v_mfma_f32_32x32x16_bf16 v[112:127], v[216:219], a[20:23], v[112:127]
    ds_read_b128 a[12:15], v9 offset:53248
    buffer_load_dwordx4 v21, s[44:47], s83 offen offset:1024 lds
    v_xor_b32 v2, v2, v0
    v_and_b32 v2, 7, v2
    v_lshlrev_b32 v2, 4, v2
    s_waitcnt lgkmcnt(3)
    v_mfma_f32_32x32x16_bf16 v[96:111], v[220:223], a[24:27], v[96:111]
    ds_read_b128 a[16:19], v10 offset:49152
    v_lshl_add_u32 v12, v1, 10, v2
    buffer_load_short_d16_hi a234, v63, s[36:39], s98 offen offset:2048
    v_add_u32 v13, 7168, v12
    v_xor_b32 v14, 64, v12
    v_mfma_f32_32x32x16_bf16 v[112:127], v[220:223], a[28:31], v[112:127]
    ds_read_b128 a[20:23], v10 offset:53248
    v_add_u32 v15, 21504, v14
    v_add_u32 v14, 14336, v14
    v_lshrrev_b32 v3, 5, v0
    buffer_load_short_d16_hi a235, v63, s[36:39], s98 offen offset:3072
    v_mfma_f32_32x32x16_bf16 v[96:111], v[224:227], a[0:3], v[96:111]
    ds_read_b128 a[24:27], v11 offset:49152
    buffer_load_dwordx4 v22, s[44:47], s83 offen offset:2048 lds
    v_lshlrev_b32 v3, 6, v3
    v_add_u32 v3, 147456, v3
    s_lshl_b32 s101, s74, 8
    v_mfma_f32_32x32x16_bf16 v[112:127], v[224:227], a[4:7], v[112:127]
    ds_read_b128 a[28:31], v11 offset:53248
    v_add_u32 v2, s101, v3
    ds_read_b128 v[80:83], v2 offset:128
    ds_read_b128 v[84:87], v2 offset:144
    s_add_u32 s98, s85, 24576
    s_waitcnt lgkmcnt(4)
    v_mfma_f32_32x32x16_bf16 v[96:111], v[228:231], a[8:11], v[96:111]
    ds_read_b128 a[0:3], v8 offset:57344
    ds_read_b128 v[88:91], v2 offset:160
    ds_read_b128 v[92:95], v2 offset:176
    s_xor_b32 s101, s100, 1
    s_lshl_b32 s101, s101, 12
    v_mfma_f32_32x32x16_bf16 v[112:127], v[228:231], a[12:15], v[112:127]
    ds_read_b128 a[4:7], v8 offset:61440
    buffer_load_dwordx4 v23, s[44:47], s83 offen offset:3072 lds
    s_add_u32 s11, s101, s89
    buffer_load_short_d16_hi a236, v63, s[36:39], s98 offen offset:0
    s_add_u32 s8, s11, s101
    v_mfma_f32_32x32x16_bf16 v[96:111], v[232:235], a[16:19], v[96:111]
    ds_read_b128 a[8:11], v9 offset:57344
    s_add_u32 s11, s11, 28672
    s_xor_b32 s101, s100, 2
    s_lshl_b32 s101, s101, 12
    s_add_u32 s12, s101, s89
    v_mfma_f32_32x32x16_bf16 v[112:127], v[232:235], a[20:23], v[112:127]
    ds_read_b128 a[12:15], v9 offset:61440
    s_add_u32 s9, s12, s101
    buffer_load_short_d16_hi a237, v63, s[36:39], s98 offen offset:1024
    s_add_u32 s12, s12, 28672
    s_xor_b32 s101, s100, 3
    s_waitcnt lgkmcnt(2)
    v_mfma_f32_32x32x16_bf16 v[96:111], v[236:239], a[24:27], v[96:111]
    ds_read_b128 a[16:19], v10 offset:57344
    s_lshl_b32 s101, s101, 12
    s_add_u32 s13, s101, s89
    s_add_u32 s10, s13, s101
    buffer_load_short_d16_hi a238, v63, s[36:39], s98 offen offset:2048
    v_mfma_f32_32x32x16_bf16 v[112:127], v[236:239], a[28:31], v[112:127]
    ds_read_b128 a[20:23], v10 offset:61440
    s_add_u32 s13, s13, 28672
    s_lshl_b32 s101, s25, 12
    s_add_u32 s14, s101, s89
    s_lshl_b32 s101, s26, 12
    v_mfma_f32_32x32x16_bf16 v[96:111], v[240:243], a[0:3], v[96:111]
    ds_read_b128 a[24:27], v11 offset:57344
    s_add_u32 s15, s101, s89
    s_lshl_b32 s101, s100, 9
    buffer_load_short_d16_hi a239, v63, s[36:39], s98 offen offset:3072
    s_add_u32 s101, s101, s35
    v_mfma_f32_32x32x16_bf16 v[112:127], v[240:243], a[4:7], v[112:127]
    ds_read_b128 a[28:31], v11 offset:61440
    v_lshlrev_b32 v1, 3, v0
    v_mov_b32 v48, 0
    v_mov_b32 v49, 0
    buffer_store_dwordx2 v[48:49], v1, s[60:63], s101 offen sc1
    s_waitcnt lgkmcnt(2)
    v_mfma_f32_32x32x16_bf16 v[96:111], v[244:247], a[8:11], v[96:111]
    s_waitcnt vmcnt(30)
    s_barrier
    v_mfma_f32_32x32x16_bf16 v[112:127], v[244:247], a[12:15], v[112:127]
    v_xor_b32 v25, 0, v24
    ds_read_b64_tr_b16 a[128:129], v25 offset:0
    ds_read_b64_tr_b16 a[130:131], v25 offset:512
    v_mfma_f32_32x32x16_bf16 v[96:111], v[248:251], a[16:19], v[96:111]
    ds_read_b64_tr_b16 a[132:133], v25 offset:2048
    ds_read_b64_tr_b16 a[134:135], v25 offset:2560
    v_mfma_f32_32x32x16_bf16 v[112:127], v[248:251], a[20:23], v[112:127]
    ds_read_b64_tr_b16 a[136:137], v25 offset:4096
    ds_read_b64_tr_b16 a[138:139], v25 offset:4608
    s_waitcnt lgkmcnt(6)
    v_mfma_f32_32x32x16_bf16 v[96:111], v[252:255], a[24:27], v[96:111]
    ds_read_b64_tr_b16 a[140:141], v25 offset:6144
    ds_read_b64_tr_b16 a[142:143], v25 offset:6656
    v_mfma_f32_32x32x16_bf16 v[112:127], v[252:255], a[28:31], v[112:127]
    ds_read_b64_tr_b16 a[144:145], v25 offset:8192
    ds_read_b64_tr_b16 a[146:147], v25 offset:8704
    s_waitcnt lgkmcnt(8)
    v_mfma_f32_32x32x16_bf16 v[64:79], a[128:131], v[128:131], 0
    ds_read_b64_tr_b16 a[148:149], v25 offset:10240
    ds_read_b64_tr_b16 a[150:151], v25 offset:10752
    s_add_u32 m0, s82, 81920
    s_mul_i32 s83, s79, 229376
    s_add_u32 s83, s83, s88
    buffer_load_dwordx4 v20, s[44:47], s83 offen offset:0 lds
    s_waitcnt lgkmcnt(6)
    v_mfma_f32_32x32x16_bf16 v[64:79], a[132:135], v[132:135], v[64:79]
    ds_read_b64_tr_b16 a[152:153], v25 offset:12288
    ds_read_b64_tr_b16 a[154:155], v25 offset:12800
    v_mfma_f32_32x32x16_bf16 v[64:79], a[136:139], v[136:139], v[64:79]
    ds_read_b64_tr_b16 a[156:157], v25 offset:14336
    ds_read_b64_tr_b16 a[158:159], v25 offset:14848
    buffer_load_dwordx4 v21, s[44:47], s83 offen offset:1024 lds
    v_mul_f32 v48, v96, v35
    v_mul_f32 v49, v96, v36
    v_fmac_f32 v48, v112, v36
    s_waitcnt lgkmcnt(4)
    v_mfma_f32_32x32x16_bf16 v[64:79], a[140:143], v[140:143], v[64:79]
    ds_read_b64_tr_b16 a[128:129], v25 offset:16384
    ds_read_b64_tr_b16 a[130:131], v25 offset:16896
    v_fmac_f32 v49, v112, v37
    v_mul_f32 v50, v97, v35
    v_mul_f32 v51, v97, v36
    v_fmac_f32 v50, v113, v36
    v_fmac_f32 v51, v113, v37
    v_mfma_f32_32x32x16_bf16 v[64:79], a[144:147], v[144:147], v[64:79]
    ds_read_b64_tr_b16 a[132:133], v25 offset:18432
    ds_read_b64_tr_b16 a[134:135], v25 offset:18944
    buffer_load_dwordx4 v22, s[44:47], s83 offen offset:2048 lds
    v_mul_f32 v96, v48, v80
    v_mul_f32 v97, v49, v80
    v_mul_f32 v112, v50, v81
    v_mfma_f32_32x32x16_bf16 v[64:79], a[148:151], v[148:151], v[64:79]
    ds_read_b64_tr_b16 a[136:137], v25 offset:20480
    ds_read_b64_tr_b16 a[138:139], v25 offset:20992
    v_mul_f32 v113, v51, v81
    v_mul_f32 v48, v98, v35
    v_mul_f32 v49, v98, v36
    v_fmac_f32 v48, v114, v36
    s_waitcnt lgkmcnt(4)
    v_mfma_f32_32x32x16_bf16 v[64:79], a[152:155], v[152:155], v[64:79]
    ds_read_b64_tr_b16 a[140:141], v25 offset:22528
    ds_read_b64_tr_b16 a[142:143], v25 offset:23040
    buffer_load_dwordx4 v23, s[44:47], s83 offen offset:3072 lds
    v_fmac_f32 v49, v114, v37
    v_mul_f32 v50, v99, v35
    v_mul_f32 v51, v99, v36
    v_mfma_f32_32x32x16_bf16 v[64:79], a[156:159], v[156:159], v[64:79]
    ds_read_b64_tr_b16 a[144:145], v25 offset:24576
    ds_read_b64_tr_b16 a[146:147], v25 offset:25088
    v_fmac_f32 v50, v115, v36
    v_fmac_f32 v51, v115, v37
    v_mul_f32 v98, v48, v82
    v_mul_f32 v99, v49, v82
    v_mul_f32 v114, v50, v83
    v_mfma_f32_32x32x16_bf16 v[64:79], a[128:131], v[160:163], v[64:79]
    ds_read_b64_tr_b16 a[148:149], v25 offset:26624
    ds_read_b64_tr_b16 a[150:151], v25 offset:27136
    s_add_u32 m0, s82, 98304
    s_mul_i32 s83, s80, 229376
    s_add_u32 s83, s83, s88
    buffer_load_dwordx4 v20, s[44:47], s83 offen offset:0 lds
    s_waitcnt lgkmcnt(4)
    v_mfma_f32_32x32x16_bf16 v[64:79], a[132:135], v[164:167], v[64:79]
    ds_read_b64_tr_b16 a[152:153], v25 offset:28672
    ds_read_b64_tr_b16 a[154:155], v25 offset:29184
    v_mul_f32 v115, v51, v83
    v_mul_f32 v48, v100, v35
    v_mul_f32 v49, v100, v36
    v_fmac_f32 v48, v116, v36
    v_mfma_f32_32x32x16_bf16 v[64:79], a[136:139], v[168:171], v[64:79]
    ds_read_b64_tr_b16 a[156:157], v25 offset:30720
    ds_read_b64_tr_b16 a[158:159], v25 offset:31232
    buffer_load_dwordx4 v21, s[44:47], s83 offen offset:1024 lds
    s_waitcnt vmcnt(30)
    s_barrier
    v_fmac_f32 v49, v116, v37
    v_mul_f32 v50, v101, v35
    v_mfma_f32_32x32x16_bf16 v[64:79], a[140:143], v[172:175], v[64:79]
    ds_read_b64_tr_b16 a[128:129], v25 offset:32768
    ds_read_b64_tr_b16 a[130:131], v25 offset:33280
    v_mul_f32 v51, v101, v36
    v_fmac_f32 v50, v117, v36
    v_fmac_f32 v51, v117, v37
    v_mul_f32 v100, v48, v84
    s_waitcnt lgkmcnt(4)
    v_mfma_f32_32x32x16_bf16 v[64:79], a[144:147], v[176:179], v[64:79]
    ds_read_b64_tr_b16 a[132:133], v25 offset:34816
    ds_read_b64_tr_b16 a[134:135], v25 offset:35328
    buffer_load_dwordx4 v22, s[44:47], s83 offen offset:2048 lds
    v_mul_f32 v101, v49, v84
    v_mul_f32 v116, v50, v85
    v_mul_f32 v117, v51, v85
    v_mfma_f32_32x32x16_bf16 v[64:79], a[148:151], v[180:183], v[64:79]
    ds_read_b64_tr_b16 a[136:137], v25 offset:36864
    ds_read_b64_tr_b16 a[138:139], v25 offset:37376
    v_mul_f32 v48, v102, v35
    v_mul_f32 v49, v102, v36
    v_fmac_f32 v48, v118, v36
    v_fmac_f32 v49, v118, v37
    v_mfma_f32_32x32x16_bf16 v[64:79], a[152:155], v[184:187], v[64:79]
    ds_read_b64_tr_b16 a[140:141], v25 offset:38912
    ds_read_b64_tr_b16 a[142:143], v25 offset:39424
    buffer_load_dwordx4 v23, s[44:47], s83 offen offset:3072 lds
    v_mul_f32 v50, v103, v35
    v_mul_f32 v51, v103, v36
    v_fmac_f32 v50, v119, v36
    v_fmac_f32 v51, v119, v37
    s_waitcnt lgkmcnt(4)
    v_mfma_f32_32x32x16_bf16 v[64:79], a[156:159], v[188:191], v[64:79]
    ds_read_b64_tr_b16 a[144:145], v25 offset:40960
    ds_read_b64_tr_b16 a[146:147], v25 offset:41472
    v_mul_f32 v102, v48, v86
    v_mul_f32 v103, v49, v86
    v_mul_f32 v118, v50, v87
    v_mul_f32 v119, v51, v87
    v_pk_fma_f32 v[30:31], v[96:97], v[34:35], v[112:113] op_sel_hi:[1,0,1]
    v_pk_fma_f32 v[30:31], v[96:97], v[32:33], v[30:31] op_sel:[1,0,0] op_sel_hi:[0,1,1]
    v_pk_fma_f32 v[52:53], v[30:31], v[34:35], v[98:99] op_sel_hi:[1,0,1]
    v_pk_fma_f32 v[52:53], v[30:31], v[32:33], v[52:53] op_sel:[1,0,0] op_sel_hi:[0,1,1]
    v_pk_fma_f32 v[30:31], v[52:53], v[34:35], v[114:115] op_sel_hi:[1,0,1]
    v_pk_fma_f32 v[30:31], v[52:53], v[32:33], v[30:31] op_sel:[1,0,0] op_sel_hi:[0,1,1]
    v_pk_fma_f32 v[52:53], v[30:31], v[34:35], v[100:101] op_sel_hi:[1,0,1]
    v_pk_fma_f32 v[52:53], v[30:31], v[32:33], v[52:53] op_sel:[1,0,0] op_sel_hi:[0,1,1]
    v_pk_fma_f32 v[30:31], v[52:53], v[34:35], v[116:117] op_sel_hi:[1,0,1]
    v_pk_fma_f32 v[30:31], v[52:53], v[32:33], v[30:31] op_sel:[1,0,0] op_sel_hi:[0,1,1]
    v_pk_fma_f32 v[52:53], v[30:31], v[34:35], v[102:103] op_sel_hi:[1,0,1]
    v_pk_fma_f32 v[52:53], v[30:31], v[32:33], v[52:53] op_sel:[1,0,0] op_sel_hi:[0,1,1]
    v_pk_fma_f32 v[30:31], v[52:53], v[34:35], v[118:119] op_sel_hi:[1,0,1]
    v_pk_fma_f32 v[30:31], v[52:53], v[32:33], v[30:31] op_sel:[1,0,0] op_sel_hi:[0,1,1]
    v_mfma_f32_32x32x16_bf16 v[64:79], a[128:131], v[192:195], v[64:79]
    ds_read_b64_tr_b16 a[148:149], v25 offset:43008
    ds_read_b64_tr_b16 a[150:151], v25 offset:43520
    s_add_u32 m0, s82, 114688
    s_mul_i32 s83, s81, 229376
    s_add_u32 s83, s83, s88
    buffer_load_dwordx4 v20, s[44:47], s83 offen offset:0 lds
    v_mfma_f32_32x32x16_bf16 v[64:79], a[132:135], v[196:199], v[64:79]
    ds_read_b64_tr_b16 a[152:153], v25 offset:45056
    ds_read_b64_tr_b16 a[154:155], v25 offset:45568
    v_mul_f32 v48, v104, v35
    v_mul_f32 v49, v104, v36
    v_fmac_f32 v48, v120, v36
    v_fmac_f32 v49, v120, v37
    s_waitcnt lgkmcnt(4)
    v_mfma_f32_32x32x16_bf16 v[64:79], a[136:139], v[200:203], v[64:79]
    ds_read_b64_tr_b16 a[156:157], v25 offset:47104
    ds_read_b64_tr_b16 a[158:159], v25 offset:47616
    buffer_load_dwordx4 v21, s[44:47], s83 offen offset:1024 lds
    s_waitcnt vmcnt(24)
    s_barrier
    v_mul_f32 v50, v105, v35
    v_mul_f32 v51, v105, v36
    v_mfma_f32_32x32x16_bf16 v[64:79], a[140:143], v[204:207], v[64:79]
    ds_read_b64_tr_b16 a[128:129], v25 offset:49152
    ds_read_b64_tr_b16 a[130:131], v25 offset:49664
    v_fmac_f32 v50, v121, v36
    v_fmac_f32 v51, v121, v37
    v_mul_f32 v104, v48, v88
    v_mul_f32 v105, v49, v88
    v_mfma_f32_32x32x16_bf16 v[64:79], a[144:147], v[208:211], v[64:79]
    ds_read_b64_tr_b16 a[132:133], v25 offset:51200
    ds_read_b64_tr_b16 a[134:135], v25 offset:51712
    buffer_load_dwordx4 v22, s[44:47], s83 offen offset:2048 lds
    v_mul_f32 v120, v50, v89
    v_mul_f32 v121, v51, v89
    v_mul_f32 v48, v106, v35
    s_waitcnt lgkmcnt(4)
    v_mfma_f32_32x32x16_bf16 v[64:79], a[148:151], v[212:215], v[64:79]
    ds_read_b64_tr_b16 a[136:137], v25 offset:53248
    ds_read_b64_tr_b16 a[138:139], v25 offset:53760
    v_mul_f32 v49, v106, v36
    v_fmac_f32 v48, v122, v36
    v_fmac_f32 v49, v122, v37
    v_mul_f32 v50, v107, v35
    v_mfma_f32_32x32x16_bf16 v[64:79], a[152:155], v[216:219], v[64:79]
    ds_read_b64_tr_b16 a[140:141], v25 offset:55296
    ds_read_b64_tr_b16 a[142:143], v25 offset:55808
    buffer_load_dwordx4 v23, s[44:47], s83 offen offset:3072 lds
    v_mul_f32 v51, v107, v36
    v_fmac_f32 v50, v123, v36
    v_fmac_f32 v51, v123, v37
    v_mfma_f32_32x32x16_bf16 v[64:79], a[156:159], v[220:223], v[64:79]
    ds_read_b64_tr_b16 a[144:145], v25 offset:57344
    ds_read_b64_tr_b16 a[146:147], v25 offset:57856
    v_mul_f32 v106, v48, v90
    v_mul_f32 v107, v49, v90
    v_mul_f32 v122, v50, v91
    v_mul_f32 v123, v51, v91
    v_mul_f32 v48, v108, v35
    s_waitcnt lgkmcnt(4)
    v_mfma_f32_32x32x16_bf16 v[64:79], a[128:131], v[224:227], v[64:79]
    ds_read_b64_tr_b16 a[148:149], v25 offset:59392
    ds_read_b64_tr_b16 a[150:151], v25 offset:59904
    buffer_load_dword a248, v47, s[68:71], 0 offen
    v_mul_f32 v49, v108, v36
    v_fmac_f32 v48, v124, v36
    v_fmac_f32 v49, v124, v37
    v_mfma_f32_32x32x16_bf16 v[64:79], a[132:135], v[228:231], v[64:79]
    ds_read_b64_tr_b16 a[152:153], v25 offset:61440
    ds_read_b64_tr_b16 a[154:155], v25 offset:61952
    v_mul_f32 v50, v109, v35
    v_mul_f32 v51, v109, v36
    v_fmac_f32 v50, v125, v36
    v_fmac_f32 v51, v125, v37
    v_mfma_f32_32x32x16_bf16 v[64:79], a[136:139], v[232:235], v[64:79]
    ds_read_b64_tr_b16 a[156:157], v25 offset:63488
    ds_read_b64_tr_b16 a[158:159], v25 offset:64000
    v_mul_f32 v108, v48, v92
    v_mul_f32 v109, v49, v92
    v_mul_f32 v124, v50, v93
    v_mul_f32 v125, v51, v93
    s_waitcnt lgkmcnt(4)
    v_mfma_f32_32x32x16_bf16 v[64:79], a[140:143], v[236:239], v[64:79]
    v_xor_b32 v25, 64, v24
    ds_read_b64_tr_b16 a[128:129], v25 offset:0
    ds_read_b64_tr_b16 a[130:131], v25 offset:512
    v_mul_f32 v48, v110, v35
    v_mul_f32 v49, v110, v36
    v_fmac_f32 v48, v126, v36
    v_fmac_f32 v49, v126, v37
    v_mfma_f32_32x32x16_bf16 v[64:79], a[144:147], v[240:243], v[64:79]
    ds_read_b64_tr_b16 a[132:133], v25 offset:2048
    ds_read_b64_tr_b16 a[134:135], v25 offset:2560
    v_mul_f32 v50, v111, v35
    v_mul_f32 v51, v111, v36
    v_fmac_f32 v50, v127, v36
    v_fmac_f32 v51, v127, v37
    v_mfma_f32_32x32x16_bf16 v[64:79], a[148:151], v[244:247], v[64:79]
    ds_read_b64_tr_b16 a[136:137], v25 offset:4096
    ds_read_b64_tr_b16 a[138:139], v25 offset:4608
    v_mul_f32 v110, v48, v94
    v_mul_f32 v111, v49, v94
    v_mul_f32 v126, v50, v95
    v_mul_f32 v127, v51, v95
    v_pk_fma_f32 v[52:53], v[30:31], v[34:35], v[104:105] op_sel_hi:[1,0,1]
    v_pk_fma_f32 v[52:53], v[30:31], v[32:33], v[52:53] op_sel:[1,0,0] op_sel_hi:[0,1,1]
    v_pk_fma_f32 v[30:31], v[52:53], v[34:35], v[120:121] op_sel_hi:[1,0,1]
    v_pk_fma_f32 v[30:31], v[52:53], v[32:33], v[30:31] op_sel:[1,0,0] op_sel_hi:[0,1,1]
    v_pk_fma_f32 v[52:53], v[30:31], v[34:35], v[106:107] op_sel_hi:[1,0,1]
    v_pk_fma_f32 v[52:53], v[30:31], v[32:33], v[52:53] op_sel:[1,0,0] op_sel_hi:[0,1,1]
    v_pk_fma_f32 v[30:31], v[52:53], v[34:35], v[122:123] op_sel_hi:[1,0,1]
    v_pk_fma_f32 v[30:31], v[52:53], v[32:33], v[30:31] op_sel:[1,0,0] op_sel_hi:[0,1,1]
    v_pk_fma_f32 v[52:53], v[30:31], v[34:35], v[108:109] op_sel_hi:[1,0,1]
    v_pk_fma_f32 v[52:53], v[30:31], v[32:33], v[52:53] op_sel:[1,0,0] op_sel_hi:[0,1,1]
    v_pk_fma_f32 v[30:31], v[52:53], v[34:35], v[124:125] op_sel_hi:[1,0,1]
    v_pk_fma_f32 v[30:31], v[52:53], v[32:33], v[30:31] op_sel:[1,0,0] op_sel_hi:[0,1,1]
    v_pk_fma_f32 v[52:53], v[30:31], v[34:35], v[110:111] op_sel_hi:[1,0,1]
    v_pk_fma_f32 v[52:53], v[30:31], v[32:33], v[52:53] op_sel:[1,0,0] op_sel_hi:[0,1,1]
    v_pk_fma_f32 v[30:31], v[52:53], v[34:35], v[126:127] op_sel_hi:[1,0,1]
    v_pk_fma_f32 v[30:31], v[52:53], v[32:33], v[30:31] op_sel:[1,0,0] op_sel_hi:[0,1,1]
    s_waitcnt lgkmcnt(0)
    v_mfma_f32_32x32x16_bf16 v[64:79], a[152:155], v[248:251], v[64:79]
    ds_read_b64_tr_b16 a[140:141], v25 offset:6144
    ds_read_b64_tr_b16 a[142:143], v25 offset:6656
    v_accvgpr_read_b32 v2, a49
    s_mov_b32 s78, 0xbfb17218
    ds_write_b64 v2, v[30:31] offset:1792
    v_mfma_f32_32x32x16_bf16 v[64:79], a[156:159], v[252:255], v[64:79]
    ds_read_b64_tr_b16 a[144:145], v25 offset:8192
    ds_read_b64_tr_b16 a[146:147], v25 offset:8704
    s_waitcnt lgkmcnt(2)
    s_barrier
    ds_read_b128 v[52:55], v3 offset:1040
    ds_read_b128 v[48:51], v3 offset:1024
    v_mfma_f32_32x32x16_bf16 v[80:95], a[128:131], v[128:131], 0
    ds_read_b64_tr_b16 a[148:149], v25 offset:10240
    ds_read_b64_tr_b16 a[150:151], v25 offset:10752
    ds_read2_b64 v[56:59], v2 offset0:0 offset1:32
    v_mfma_f32_32x32x16_bf16 v[80:95], a[132:135], v[132:135], v[80:95]
    ds_read_b64_tr_b16 a[152:153], v25 offset:12288
    ds_read_b64_tr_b16 a[154:155], v25 offset:12800
    ds_read2_b64 v[60:63], v2 offset0:64 offset1:96
    v_mfma_f32_32x32x16_bf16 v[80:95], a[136:139], v[136:139], v[80:95]
    ds_read_b64_tr_b16 a[156:157], v25 offset:14336
    ds_read_b64_tr_b16 a[158:159], v25 offset:14848
    s_waitcnt lgkmcnt(8)
    v_pk_fma_f32 v[48:49], v[64:65], v[26:27], v[48:49] op_sel_hi:[1,0,1]
    v_pk_fma_f32 v[50:51], v[66:67], v[26:27], v[50:51] op_sel_hi:[1,0,1]
    v_pk_fma_f32 v[52:53], v[68:69], v[26:27], v[52:53] op_sel_hi:[1,0,1]
    v_pk_fma_f32 v[54:55], v[70:71], v[26:27], v[54:55] op_sel_hi:[1,0,1]
    v_mfma_f32_32x32x16_bf16 v[80:95], a[140:143], v[140:143], v[80:95]
    ds_read_b64_tr_b16 a[128:129], v25 offset:16384
    ds_read_b64_tr_b16 a[130:131], v25 offset:16896
    v_exp_f32 v64, v48
    v_mfma_f32_32x32x16_bf16 v[80:95], a[144:147], v[144:147], v[80:95]
    ds_read_b64_tr_b16 a[132:133], v25 offset:18432
    ds_read_b64_tr_b16 a[134:135], v25 offset:18944
    v_exp_f32 v65, v49
    v_exp_f32 v66, v50
    s_waitcnt lgkmcnt(4)
    v_mfma_f32_32x32x16_bf16 v[80:95], a[148:151], v[148:151], v[80:95]
    ds_read_b64_tr_b16 a[136:137], v25 offset:20480
    ds_read_b64_tr_b16 a[138:139], v25 offset:20992
    v_exp_f32 v67, v51
    v_exp_f32 v68, v52
    v_mfma_f32_32x32x16_bf16 v[80:95], a[152:155], v[152:155], v[80:95]
    ds_read_b64_tr_b16 a[140:141], v25 offset:22528
    ds_read_b64_tr_b16 a[142:143], v25 offset:23040
    v_exp_f32 v69, v53
    v_mfma_f32_32x32x16_bf16 v[80:95], a[156:159], v[156:159], v[80:95]
    ds_read_b64_tr_b16 a[144:145], v25 offset:24576
    ds_read_b64_tr_b16 a[146:147], v25 offset:25088
    v_exp_f32 v70, v54
    v_exp_f32 v71, v55
    v_pk_fma_f32 v[46:47], v[56:57], v[38:39], v[58:59] op_sel_hi:[1,0,1]
    v_pk_fma_f32 v[46:47], v[56:57], v[38:39], v[46:47] op_sel:[1,1,0] op_sel_hi:[0,1,1] neg_lo:[0,1,0]
    v_pk_fma_f32 v[8:9], v[46:47], v[38:39], v[60:61] op_sel_hi:[1,0,1]
    v_pk_fma_f32 v[8:9], v[46:47], v[38:39], v[8:9] op_sel:[1,1,0] op_sel_hi:[0,1,1] neg_lo:[0,1,0]
    v_pk_fma_f32 v[46:47], v[8:9], v[38:39], v[62:63] op_sel_hi:[1,0,1]
    v_pk_fma_f32 v[46:47], v[8:9], v[38:39], v[46:47] op_sel:[1,1,0] op_sel_hi:[0,1,1] neg_lo:[0,1,0]
    v_pk_add_f32 v[64:65], v[64:65], 1.0 op_sel_hi:[1,0]
    v_pk_add_f32 v[66:67], v[66:67], 1.0 op_sel_hi:[1,0]
    v_pk_add_f32 v[68:69], v[68:69], 1.0 op_sel_hi:[1,0]
    v_pk_add_f32 v[70:71], v[70:71], 1.0 op_sel_hi:[1,0]
    v_pk_fma_f32 v[64:65], v[64:65], v[64:65], 1.0 op_sel_hi:[1,1,0]
    v_pk_fma_f32 v[66:67], v[66:67], v[66:67], 1.0 op_sel_hi:[1,1,0]
    v_pk_fma_f32 v[68:69], v[68:69], v[68:69], 1.0 op_sel_hi:[1,1,0]
    v_pk_fma_f32 v[70:71], v[70:71], v[70:71], 1.0 op_sel_hi:[1,1,0]
    s_waitcnt lgkmcnt(0)
    v_mfma_f32_32x32x16_bf16 v[80:95], a[128:131], v[160:163], v[80:95]
    ds_read_b64_tr_b16 a[148:149], v25 offset:26624
    ds_read_b64_tr_b16 a[150:151], v25 offset:27136
    ds_read2_b64 v[56:59], v2 offset0:128 offset1:160
    ds_read_b64 v[60:61], v2 offset:1536
    v_rcp_f32 v64, v64
    v_mfma_f32_32x32x16_bf16 v[80:95], a[132:135], v[164:167], v[80:95]
    ds_read_b64_tr_b16 a[152:153], v25 offset:28672
    ds_read_b64_tr_b16 a[154:155], v25 offset:29184
    v_rcp_f32 v65, v65
    v_mfma_f32_32x32x16_bf16 v[80:95], a[136:139], v[168:171], v[80:95]
    ds_read_b64_tr_b16 a[156:157], v25 offset:30720
    ds_read_b64_tr_b16 a[158:159], v25 offset:31232
    v_rcp_f32 v66, v66
    v_rcp_f32 v67, v67
    v_mfma_f32_32x32x16_bf16 v[80:95], a[140:143], v[172:175], v[80:95]
    ds_read_b64_tr_b16 a[128:129], v25 offset:32768
    ds_read_b64_tr_b16 a[130:131], v25 offset:33280
    v_rcp_f32 v68, v68
    v_rcp_f32 v69, v69
    v_mfma_f32_32x32x16_bf16 v[80:95], a[144:147], v[176:179], v[80:95]
    ds_read_b64_tr_b16 a[132:133], v25 offset:34816
    ds_read_b64_tr_b16 a[134:135], v25 offset:35328
    v_rcp_f32 v70, v70
    v_rcp_f32 v71, v71
    s_waitcnt lgkmcnt(4)
    v_pk_fma_f32 v[8:9], v[46:47], v[38:39], v[56:57] op_sel_hi:[1,0,1]
    v_pk_fma_f32 v[8:9], v[46:47], v[38:39], v[8:9] op_sel:[1,1,0] op_sel_hi:[0,1,1] neg_lo:[0,1,0]
    v_pk_fma_f32 v[10:11], v[8:9], v[38:39], v[58:59] op_sel_hi:[1,0,1]
    ds_read_b128 v[56:59], v3 offset:1056
    v_pk_fma_f32 v[10:11], v[8:9], v[38:39], v[10:11] op_sel:[1,1,0] op_sel_hi:[0,1,1] neg_lo:[0,1,0]
    v_pk_fma_f32 v[46:47], v[10:11], v[38:39], v[60:61] op_sel_hi:[1,0,1]
    ds_read_b128 v[60:63], v3 offset:1072
    v_pk_fma_f32 v[46:47], v[10:11], v[38:39], v[46:47] op_sel:[1,1,0] op_sel_hi:[0,1,1] neg_lo:[0,1,0]
    v_pk_fma_f32 v[64:65], v[64:65], s[78:79], v[26:27] op_sel:[0,0,1] op_sel_hi:[1,0,1]
    v_pk_fma_f32 v[66:67], v[66:67], s[78:79], v[26:27] op_sel:[0,0,1] op_sel_hi:[1,0,1]
    v_pk_fma_f32 v[68:69], v[68:69], s[78:79], v[26:27] op_sel:[0,0,1] op_sel_hi:[1,0,1]
    v_pk_fma_f32 v[70:71], v[70:71], s[78:79], v[26:27] op_sel:[0,0,1] op_sel_hi:[1,0,1]
    v_pk_mul_f32 v[48:49], v[48:49], v[64:65]
    v_pk_mul_f32 v[50:51], v[50:51], v[66:67]
    v_pk_mul_f32 v[52:53], v[52:53], v[68:69]
    v_pk_mul_f32 v[54:55], v[54:55], v[70:71]
    v_mfma_f32_32x32x16_bf16 v[80:95], a[148:151], v[180:183], v[80:95]
    ds_read_b64_tr_b16 a[136:137], v25 offset:36864
    ds_read_b64_tr_b16 a[138:139], v25 offset:37376
    v_fma_f32 v8, v38, v46, v30
    v_fma_f32 v10, v38, v47, v31
    v_mfma_f32_32x32x16_bf16 v[80:95], a[152:155], v[184:187], v[80:95]
    ds_read_b64_tr_b16 a[140:141], v25 offset:38912
    ds_read_b64_tr_b16 a[142:143], v25 offset:39424
    v_fma_f32 v8, -v39, v47, v8
    v_fmac_f32 v10, v39, v46
    v_accvgpr_read_b32 v2, a48
    v_mov_b32 v9, s76
    v_mfma_f32_32x32x16_bf16 v[80:95], a[156:159], v[188:191], v[80:95]
    ds_read_b64_tr_b16 a[144:145], v25 offset:40960
    ds_read_b64_tr_b16 a[146:147], v25 offset:41472
    v_mov_b32 v11, s76
    buffer_store_dwordx4 v[8:11], v2, s[60:63], 0 offen sc1
    v_cvt_pk_bf16_f32 v64, v48, v49
    s_waitcnt lgkmcnt(4)
    v_mfma_f32_32x32x16_bf16 v[80:95], a[128:131], v[192:195], v[80:95]
    ds_read_b64_tr_b16 a[148:149], v25 offset:43008
    ds_read_b64_tr_b16 a[150:151], v25 offset:43520
    v_cvt_pk_bf16_f32 v65, v50, v51
    v_cvt_pk_bf16_f32 v66, v52, v53
    v_cvt_pk_bf16_f32 v67, v54, v55
    v_mfma_f32_32x32x16_bf16 v[80:95], a[132:135], v[196:199], v[80:95]
    ds_read_b64_tr_b16 a[152:153], v25 offset:45056
    ds_read_b64_tr_b16 a[154:155], v25 offset:45568
    s_add_u32 m0, s82, 131072
    s_xor_b32 s83, s100, 0
    s_lshl_b32 s83, s83, 17
    s_add_u32 s83, s83, s96
    buffer_load_dwordx4 v12, s[56:59], s83 offen offset:0 lds
    v_pk_fma_f32 v[56:57], v[72:73], v[26:27], v[56:57] op_sel_hi:[1,0,1]
    v_pk_fma_f32 v[58:59], v[74:75], v[26:27], v[58:59] op_sel_hi:[1,0,1]
    v_pk_fma_f32 v[60:61], v[76:77], v[26:27], v[60:61] op_sel_hi:[1,0,1]
    v_pk_fma_f32 v[62:63], v[78:79], v[26:27], v[62:63] op_sel_hi:[1,0,1]
    v_mfma_f32_32x32x16_bf16 v[80:95], a[136:139], v[200:203], v[80:95]
    ds_read_b64_tr_b16 a[156:157], v25 offset:47104
    ds_read_b64_tr_b16 a[158:159], v25 offset:47616
    v_exp_f32 v72, v56
    v_exp_f32 v73, v57
    s_waitcnt lgkmcnt(2)
    v_mfma_f32_32x32x16_bf16 v[80:95], a[140:143], v[204:207], v[80:95]
    ds_read_b64_tr_b16 a[128:129], v25 offset:49152
    ds_read_b64_tr_b16 a[130:131], v25 offset:49664
    buffer_load_dwordx4 v13, s[56:59], s83 offen offset:1024 lds
    v_exp_f32 v74, v58
    v_mfma_f32_32x32x16_bf16 v[80:95], a[144:147], v[208:211], v[80:95]
    ds_read_b64_tr_b16 a[132:133], v25 offset:51200
    ds_read_b64_tr_b16 a[134:135], v25 offset:51712
    v_exp_f32 v75, v59
    v_exp_f32 v76, v60
    v_mfma_f32_32x32x16_bf16 v[80:95], a[148:151], v[212:215], v[80:95]
    ds_read_b64_tr_b16 a[136:137], v25 offset:53248
    ds_read_b64_tr_b16 a[138:139], v25 offset:53760
    buffer_load_dwordx4 v14, s[56:59], s83 offen offset:2048 lds
    v_exp_f32 v77, v61
    v_mfma_f32_32x32x16_bf16 v[80:95], a[152:155], v[216:219], v[80:95]
    ds_read_b64_tr_b16 a[140:141], v25 offset:55296
    ds_read_b64_tr_b16 a[142:143], v25 offset:55808
    v_exp_f32 v78, v62
    v_exp_f32 v79, v63
    v_pk_add_f32 v[72:73], v[72:73], 1.0 op_sel_hi:[1,0]
    v_pk_add_f32 v[74:75], v[74:75], 1.0 op_sel_hi:[1,0]
    v_pk_add_f32 v[76:77], v[76:77], 1.0 op_sel_hi:[1,0]
    v_pk_add_f32 v[78:79], v[78:79], 1.0 op_sel_hi:[1,0]
    v_pk_fma_f32 v[72:73], v[72:73], v[72:73], 1.0 op_sel_hi:[1,1,0]
    v_pk_fma_f32 v[74:75], v[74:75], v[74:75], 1.0 op_sel_hi:[1,1,0]
    v_pk_fma_f32 v[76:77], v[76:77], v[76:77], 1.0 op_sel_hi:[1,1,0]
    v_pk_fma_f32 v[78:79], v[78:79], v[78:79], 1.0 op_sel_hi:[1,1,0]
    s_waitcnt lgkmcnt(2)
    v_mfma_f32_32x32x16_bf16 v[80:95], a[156:159], v[220:223], v[80:95]
    ds_read_b64_tr_b16 a[144:145], v25 offset:57344
    ds_read_b64_tr_b16 a[146:147], v25 offset:57856
    buffer_load_dwordx4 v15, s[56:59], s83 offen offset:3072 lds
    v_rcp_f32 v72, v72
    v_mfma_f32_32x32x16_bf16 v[80:95], a[128:131], v[224:227], v[80:95]
    ds_read_b64_tr_b16 a[148:149], v25 offset:59392
    ds_read_b64_tr_b16 a[150:151], v25 offset:59904
    v_rcp_f32 v73, v73
    v_rcp_f32 v74, v74
    v_mfma_f32_32x32x16_bf16 v[80:95], a[132:135], v[228:231], v[80:95]
    ds_read_b64_tr_b16 a[152:153], v25 offset:61440
    ds_read_b64_tr_b16 a[154:155], v25 offset:61952
    v_rcp_f32 v75, v75
    v_rcp_f32 v76, v76
    v_rcp_f32 v77, v77
    v_mfma_f32_32x32x16_bf16 v[80:95], a[136:139], v[232:235], v[80:95]
    ds_read_b64_tr_b16 a[156:157], v25 offset:63488
    ds_read_b64_tr_b16 a[158:159], v25 offset:64000
    s_waitcnt vmcnt(6)
    s_barrier
    v_rcp_f32 v78, v78
    s_waitcnt lgkmcnt(4)
    v_mfma_f32_32x32x16_bf16 v[80:95], a[140:143], v[236:239], v[80:95]
    v_xor_b32 v25, s97, v24
    v_add_u32 v25, 65536, v25
    ds_read_b64_tr_b16 a[128:129], v25 offset:0
    ds_read_b64_tr_b16 a[130:131], v25 offset:512
    v_rcp_f32 v79, v79
    v_pk_fma_f32 v[72:73], v[72:73], s[78:79], v[26:27] op_sel:[0,0,1] op_sel_hi:[1,0,1]
    v_pk_fma_f32 v[74:75], v[74:75], s[78:79], v[26:27] op_sel:[0,0,1] op_sel_hi:[1,0,1]
    v_pk_fma_f32 v[76:77], v[76:77], s[78:79], v[26:27] op_sel:[0,0,1] op_sel_hi:[1,0,1]
    v_pk_fma_f32 v[78:79], v[78:79], s[78:79], v[26:27] op_sel:[0,0,1] op_sel_hi:[1,0,1]
    v_pk_mul_f32 v[56:57], v[56:57], v[72:73]
    v_pk_mul_f32 v[58:59], v[58:59], v[74:75]
    v_pk_mul_f32 v[60:61], v[60:61], v[76:77]
    v_pk_mul_f32 v[62:63], v[62:63], v[78:79]
    v_mfma_f32_32x32x16_bf16 v[80:95], a[144:147], v[240:243], v[80:95]
    ds_read_b64_tr_b16 a[132:133], v25 offset:2048
    ds_read_b64_tr_b16 a[134:135], v25 offset:2560
    v_cvt_pk_bf16_f32 v68, v56, v57
    v_cvt_pk_bf16_f32 v69, v58, v59
    v_cvt_pk_bf16_f32 v70, v60, v61
    v_cvt_pk_bf16_f32 v71, v62, v63
    v_permlane16_swap_b32 v64, v68
    ds_read_b128 v[48:51], v3 offset:1152
    v_mfma_f32_32x32x16_bf16 v[80:95], a[148:151], v[244:247], v[80:95]
    ds_read_b64_tr_b16 a[136:137], v25 offset:4096
    ds_read_b64_tr_b16 a[138:139], v25 offset:4608
    ds_read_b128 v[52:55], v3 offset:1168
    ds_read_b128 v[56:59], v3 offset:1184
    ds_read_b128 v[60:63], v3 offset:1200
    v_permlane16_swap_b32 v65, v69
    v_permlane16_swap_b32 v66, v70
    v_permlane16_swap_b32 v67, v71
    buffer_store_dwordx4 v[64:67], v28, s[60:63], s90 offen offset:0 sc1
    s_waitcnt lgkmcnt(6)
    v_mfma_f32_32x32x16_bf16 v[80:95], a[152:155], v[248:251], v[80:95]
    ds_read_b64_tr_b16 a[140:141], v25 offset:6144
    ds_read_b64_tr_b16 a[142:143], v25 offset:6656
    v_accvgpr_write_b32 a64, v64
    v_accvgpr_write_b32 a65, v65
    v_accvgpr_write_b32 a66, v66
    v_accvgpr_write_b32 a67, v67
    buffer_store_dwordx4 v[68:71], v28, s[60:63], s90 offen offset:1024 sc1
    v_mfma_f32_32x32x16_bf16 v[80:95], a[156:159], v[252:255], v[80:95]
    ds_read_b64_tr_b16 a[144:145], v25 offset:8192
    ds_read_b64_tr_b16 a[146:147], v25 offset:8704
    v_accvgpr_write_b32 a68, v68
    v_accvgpr_write_b32 a69, v69
    v_accvgpr_write_b32 a70, v70
    v_accvgpr_write_b32 a71, v71
    v_mfma_f32_32x32x16_bf16 v[64:79], a[128:131], v[128:131], 0
    ds_read_b64_tr_b16 a[148:149], v25 offset:10240
    ds_read_b64_tr_b16 a[150:151], v25 offset:10752
    s_add_u32 m0, s82, 0
    s_xor_b32 s83, s95, 0
    buffer_load_dwordx4 v16, s[48:51], s83 offen offset:0 lds
    v_mfma_f32_32x32x16_bf16 v[64:79], a[132:135], v[132:135], v[64:79]
    ds_read_b64_tr_b16 a[152:153], v25 offset:12288
    ds_read_b64_tr_b16 a[154:155], v25 offset:12800
    v_accvgpr_read_b32 v35, a50
    s_waitcnt lgkmcnt(4)
    v_mfma_f32_32x32x16_bf16 v[64:79], a[136:139], v[136:139], v[64:79]
    ds_read_b64_tr_b16 a[156:157], v25 offset:14336
    ds_read_b64_tr_b16 a[158:159], v25 offset:14848
    buffer_load_dwordx4 v17, s[48:51], s83 offen offset:1024 lds
    v_accvgpr_read_b32 v36, a51
    v_accvgpr_read_b32 v37, a52
    v_accvgpr_read_b32 v38, a53
    v_pk_fma_f32 v[48:49], v[80:81], v[26:27], v[48:49] op_sel_hi:[1,0,1]
    v_pk_fma_f32 v[50:51], v[82:83], v[26:27], v[50:51] op_sel_hi:[1,0,1]
    v_pk_fma_f32 v[52:53], v[84:85], v[26:27], v[52:53] op_sel_hi:[1,0,1]
    v_pk_fma_f32 v[54:55], v[86:87], v[26:27], v[54:55] op_sel_hi:[1,0,1]
    v_mfma_f32_32x32x16_bf16 v[64:79], a[140:143], v[140:143], v[64:79]
    ds_read_b64_tr_b16 a[128:129], v25 offset:16384
    ds_read_b64_tr_b16 a[130:131], v25 offset:16896
    v_exp_f32 v80, v48
    v_exp_f32 v81, v49
    v_mfma_f32_32x32x16_bf16 v[64:79], a[144:147], v[144:147], v[64:79]
    ds_read_b64_tr_b16 a[132:133], v25 offset:18432
    ds_read_b64_tr_b16 a[134:135], v25 offset:18944
    buffer_load_dwordx4 v18, s[48:51], s83 offen offset:2048 lds
    s_barrier
    v_exp_f32 v82, v50
    v_exp_f32 v83, v51
    s_waitcnt lgkmcnt(4)
    v_mfma_f32_32x32x16_bf16 v[64:79], a[148:151], v[148:151], v[64:79]
    ds_read_b64_tr_b16 a[136:137], v25 offset:20480
    ds_read_b64_tr_b16 a[138:139], v25 offset:20992
    v_exp_f32 v84, v52
    v_exp_f32 v85, v53
    v_mfma_f32_32x32x16_bf16 v[64:79], a[152:155], v[152:155], v[64:79]
    ds_read_b64_tr_b16 a[140:141], v25 offset:22528
    ds_read_b64_tr_b16 a[142:143], v25 offset:23040
    buffer_load_dwordx4 v19, s[48:51], s83 offen offset:3072 lds
    v_exp_f32 v86, v54
    v_exp_f32 v87, v55
    v_pk_add_f32 v[80:81], v[80:81], 1.0 op_sel_hi:[1,0]
    v_pk_add_f32 v[82:83], v[82:83], 1.0 op_sel_hi:[1,0]
    v_pk_add_f32 v[84:85], v[84:85], 1.0 op_sel_hi:[1,0]
    v_pk_add_f32 v[86:87], v[86:87], 1.0 op_sel_hi:[1,0]
    v_pk_fma_f32 v[80:81], v[80:81], v[80:81], 1.0 op_sel_hi:[1,1,0]
    v_pk_fma_f32 v[82:83], v[82:83], v[82:83], 1.0 op_sel_hi:[1,1,0]
    v_pk_fma_f32 v[84:85], v[84:85], v[84:85], 1.0 op_sel_hi:[1,1,0]
    v_pk_fma_f32 v[86:87], v[86:87], v[86:87], 1.0 op_sel_hi:[1,1,0]
    v_pk_fma_f32 v[56:57], v[88:89], v[26:27], v[56:57] op_sel_hi:[1,0,1]
    v_pk_fma_f32 v[58:59], v[90:91], v[26:27], v[58:59] op_sel_hi:[1,0,1]
    v_pk_fma_f32 v[60:61], v[92:93], v[26:27], v[60:61] op_sel_hi:[1,0,1]
    v_pk_fma_f32 v[62:63], v[94:95], v[26:27], v[62:63] op_sel_hi:[1,0,1]
    v_mfma_f32_32x32x16_bf16 v[64:79], a[156:159], v[156:159], v[64:79]
    ds_read_b64_tr_b16 a[144:145], v25 offset:24576
    ds_read_b64_tr_b16 a[146:147], v25 offset:25088
    s_add_u32 m0, s82, 16384
    s_xor_b32 s83, s95, 0
    buffer_load_dwordx4 v16, s[52:55], s83 offen offset:0 lds
    v_rcp_f32 v80, v80
    s_waitcnt lgkmcnt(2)
    v_mfma_f32_32x32x16_bf16 v[64:79], a[128:131], v[160:163], v[64:79]
    ds_read_b64_tr_b16 a[148:149], v25 offset:26624
    ds_read_b64_tr_b16 a[150:151], v25 offset:27136
    v_rcp_f32 v81, v81
    v_rcp_f32 v82, v82
    v_mfma_f32_32x32x16_bf16 v[64:79], a[132:135], v[164:167], v[64:79]
    ds_read_b64_tr_b16 a[152:153], v25 offset:28672
    ds_read_b64_tr_b16 a[154:155], v25 offset:29184
    buffer_load_dwordx4 v17, s[52:55], s83 offen offset:1024 lds
    v_rcp_f32 v83, v83
    v_rcp_f32 v84, v84
    v_mfma_f32_32x32x16_bf16 v[64:79], a[136:139], v[168:171], v[64:79]
    ds_read_b64_tr_b16 a[156:157], v25 offset:30720
    ds_read_b64_tr_b16 a[158:159], v25 offset:31232
    v_rcp_f32 v85, v85
    v_rcp_f32 v86, v86
    v_rcp_f32 v87, v87
    v_mfma_f32_32x32x16_bf16 v[64:79], a[140:143], v[172:175], v[64:79]
    ds_read_b64_tr_b16 a[128:129], v25 offset:32768
    ds_read_b64_tr_b16 a[130:131], v25 offset:33280
    buffer_load_dwordx4 v18, s[52:55], s83 offen offset:2048 lds
    v_exp_f32 v88, v56
    v_exp_f32 v89, v57
    s_waitcnt lgkmcnt(3)
    v_mfma_f32_32x32x16_bf16 v[64:79], a[144:147], v[176:179], v[64:79]
    ds_read_b64_tr_b16 a[132:133], v25 offset:34816
    ds_read_b64_tr_b16 a[134:135], v25 offset:35328
    v_exp_f32 v90, v58
    v_exp_f32 v91, v59
    v_mfma_f32_32x32x16_bf16 v[64:79], a[148:151], v[180:183], v[64:79]
    ds_read_b64_tr_b16 a[136:137], v25 offset:36864
    ds_read_b64_tr_b16 a[138:139], v25 offset:37376
    buffer_load_dwordx4 v19, s[52:55], s83 offen offset:3072 lds
    v_exp_f32 v92, v60
    v_exp_f32 v93, v61
    v_mfma_f32_32x32x16_bf16 v[64:79], a[152:155], v[184:187], v[64:79]
    ds_read_b64_tr_b16 a[140:141], v25 offset:38912
    ds_read_b64_tr_b16 a[142:143], v25 offset:39424
    buffer_load_dwordx4 v[8:11], v35, s[60:63], 0 offen sc1
    buffer_load_dwordx4 v[20:23], v36, s[60:63], 0 offen sc1
    v_exp_f32 v94, v62
    v_exp_f32 v95, v63
    v_pk_fma_f32 v[80:81], v[80:81], s[78:79], v[26:27] op_sel:[0,0,1] op_sel_hi:[1,0,1]
    v_pk_fma_f32 v[82:83], v[82:83], s[78:79], v[26:27] op_sel:[0,0,1] op_sel_hi:[1,0,1]
    v_pk_fma_f32 v[84:85], v[84:85], s[78:79], v[26:27] op_sel:[0,0,1] op_sel_hi:[1,0,1]
    v_pk_fma_f32 v[86:87], v[86:87], s[78:79], v[26:27] op_sel:[0,0,1] op_sel_hi:[1,0,1]
    v_pk_mul_f32 v[48:49], v[48:49], v[80:81]
    v_pk_mul_f32 v[50:51], v[50:51], v[82:83]
    v_pk_mul_f32 v[52:53], v[52:53], v[84:85]
    v_pk_mul_f32 v[54:55], v[54:55], v[86:87]
    v_pk_add_f32 v[88:89], v[88:89], 1.0 op_sel_hi:[1,0]
    v_pk_add_f32 v[90:91], v[90:91], 1.0 op_sel_hi:[1,0]
    v_pk_add_f32 v[92:93], v[92:93], 1.0 op_sel_hi:[1,0]
    v_pk_add_f32 v[94:95], v[94:95], 1.0 op_sel_hi:[1,0]
    v_pk_fma_f32 v[88:89], v[88:89], v[88:89], 1.0 op_sel_hi:[1,1,0]
    v_pk_fma_f32 v[90:91], v[90:91], v[90:91], 1.0 op_sel_hi:[1,1,0]
    v_pk_fma_f32 v[92:93], v[92:93], v[92:93], 1.0 op_sel_hi:[1,1,0]
    v_pk_fma_f32 v[94:95], v[94:95], v[94:95], 1.0 op_sel_hi:[1,1,0]
    s_waitcnt lgkmcnt(0)
    v_mfma_f32_32x32x16_bf16 v[64:79], a[156:159], v[188:191], v[64:79]
    ds_read_b64_tr_b16 a[144:145], v25 offset:40960
    ds_read_b64_tr_b16 a[146:147], v25 offset:41472
    s_add_u32 m0, s82, 32768
    s_xor_b32 s83, s100, 1
    s_lshl_b32 s83, s83, 17
    s_add_u32 s83, s83, s96
    buffer_load_dwordx4 v12, s[56:59], s83 offen offset:0 lds
    v_mfma_f32_32x32x16_bf16 v[64:79], a[128:131], v[192:195], v[64:79]
    ds_read_b64_tr_b16 a[148:149], v25 offset:43008
    ds_read_b64_tr_b16 a[150:151], v25 offset:43520
    v_cvt_pk_bf16_f32 v80, v48, v49
    v_cvt_pk_bf16_f32 v81, v50, v51
    v_cvt_pk_bf16_f32 v82, v52, v53
    v_mfma_f32_32x32x16_bf16 v[64:79], a[132:135], v[196:199], v[64:79]
    ds_read_b64_tr_b16 a[152:153], v25 offset:45056
    ds_read_b64_tr_b16 a[154:155], v25 offset:45568
    buffer_load_dwordx4 v13, s[56:59], s83 offen offset:1024 lds
    v_cvt_pk_bf16_f32 v83, v54, v55
    v_rcp_f32 v88, v88
    v_mfma_f32_32x32x16_bf16 v[64:79], a[136:139], v[200:203], v[64:79]
    ds_read_b64_tr_b16 a[156:157], v25 offset:47104
    ds_read_b64_tr_b16 a[158:159], v25 offset:47616
    v_rcp_f32 v89, v89
    v_rcp_f32 v90, v90
    v_mfma_f32_32x32x16_bf16 v[64:79], a[140:143], v[204:207], v[64:79]
    ds_read_b64_tr_b16 a[128:129], v25 offset:49152
    ds_read_b64_tr_b16 a[130:131], v25 offset:49664
    buffer_load_dwordx4 v14, s[56:59], s83 offen offset:2048 lds
    v_rcp_f32 v91, v91
    s_waitcnt lgkmcnt(4)
    v_mfma_f32_32x32x16_bf16 v[64:79], a[144:147], v[208:211], v[64:79]
    ds_read_b64_tr_b16 a[132:133], v25 offset:51200
    ds_read_b64_tr_b16 a[134:135], v25 offset:51712
    v_rcp_f32 v92, v92
    v_rcp_f32 v93, v93
    v_mfma_f32_32x32x16_bf16 v[64:79], a[148:151], v[212:215], v[64:79]
    ds_read_b64_tr_b16 a[136:137], v25 offset:53248
    ds_read_b64_tr_b16 a[138:139], v25 offset:53760
    buffer_load_dwordx4 v15, s[56:59], s83 offen offset:3072 lds
    v_rcp_f32 v94, v94
    v_rcp_f32 v95, v95
    v_pk_fma_f32 v[88:89], v[88:89], s[78:79], v[26:27] op_sel:[0,0,1] op_sel_hi:[1,0,1]
    v_pk_fma_f32 v[90:91], v[90:91], s[78:79], v[26:27] op_sel:[0,0,1] op_sel_hi:[1,0,1]
    v_pk_fma_f32 v[92:93], v[92:93], s[78:79], v[26:27] op_sel:[0,0,1] op_sel_hi:[1,0,1]
    v_pk_fma_f32 v[94:95], v[94:95], s[78:79], v[26:27] op_sel:[0,0,1] op_sel_hi:[1,0,1]
    v_pk_mul_f32 v[56:57], v[56:57], v[88:89]
    v_pk_mul_f32 v[58:59], v[58:59], v[90:91]
    v_pk_mul_f32 v[60:61], v[60:61], v[92:93]
    v_pk_mul_f32 v[62:63], v[62:63], v[94:95]
    v_mfma_f32_32x32x16_bf16 v[64:79], a[152:155], v[216:219], v[64:79]
    ds_read_b64_tr_b16 a[140:141], v25 offset:55296
    ds_read_b64_tr_b16 a[142:143], v25 offset:55808
    s_add_u32 m0, s82, 49152
    s_xor_b32 s83, s100, 2
    s_lshl_b32 s83, s83, 17
    s_add_u32 s83, s83, s96
    buffer_load_dwordx4 v12, s[56:59], s83 offen offset:0 lds
    v_cvt_pk_bf16_f32 v84, v56, v57
    v_cvt_pk_bf16_f32 v85, v58, v59
    s_waitcnt lgkmcnt(2)
    v_mfma_f32_32x32x16_bf16 v[64:79], a[156:159], v[220:223], v[64:79]
    ds_read_b64_tr_b16 a[144:145], v25 offset:57344
    ds_read_b64_tr_b16 a[146:147], v25 offset:57856
    v_cvt_pk_bf16_f32 v86, v60, v61
    v_cvt_pk_bf16_f32 v87, v62, v63
    v_permlane16_swap_b32 v80, v84
    v_permlane16_swap_b32 v81, v85
    v_permlane16_swap_b32 v82, v86
    v_permlane16_swap_b32 v83, v87
    v_mfma_f32_32x32x16_bf16 v[64:79], a[128:131], v[224:227], v[64:79]
    ds_read_b64_tr_b16 a[148:149], v25 offset:59392
    ds_read_b64_tr_b16 a[150:151], v25 offset:59904
    buffer_load_dwordx4 v13, s[56:59], s83 offen offset:1024 lds
    buffer_store_dwordx4 v[80:83], v28, s[60:63], s91 offen offset:0 sc1
    v_accvgpr_write_b32 a72, v80
    v_accvgpr_write_b32 a73, v81
    v_accvgpr_write_b32 a74, v82
    v_accvgpr_write_b32 a75, v83
    buffer_store_dwordx4 v[84:87], v28, s[60:63], s91 offen offset:1024 sc1
    v_mfma_f32_32x32x16_bf16 v[64:79], a[132:135], v[228:231], v[64:79]
    ds_read_b64_tr_b16 a[152:153], v25 offset:61440
    ds_read_b64_tr_b16 a[154:155], v25 offset:61952
    v_accvgpr_write_b32 a76, v84
    v_accvgpr_write_b32 a77, v85
    v_accvgpr_write_b32 a78, v86
    v_accvgpr_write_b32 a79, v87
    s_waitcnt vmcnt(9)
    v_bitop3_b32 v1, v9, v11, v37 bitop3:0x7e
    s_waitcnt vmcnt(8)
    v_bitop3_b32 v2, v21, v23, v38 bitop3:0x7e
    v_mfma_f32_32x32x16_bf16 v[64:79], a[136:139], v[232:235], v[64:79]
    ds_read_b64_tr_b16 a[156:157], v25 offset:63488
    ds_read_b64_tr_b16 a[158:159], v25 offset:64000
    buffer_load_dwordx4 v14, s[56:59], s83 offen offset:2048 lds
    v_or_b32 v1, v1, v2
    v_cmp_ne_u32 vcc, 0, v1
    s_cbranch_vccnz L_retry_lb
L_back_lb:
    v_fma_f32 v9, v42, v8, v20
    v_fma_f32 v11, v42, v10, v22
    v_fma_f32 v9, -v43, v10, v9
    s_waitcnt lgkmcnt(2)
    v_mfma_f32_32x32x16_bf16 v[64:79], a[140:143], v[236:239], v[64:79]
    v_xor_b32 v25, 64, v25
    ds_read_b64_tr_b16 a[128:129], v25 offset:0
    ds_read_b64_tr_b16 a[130:131], v25 offset:512
    v_fmac_f32 v11, v43, v8
    v_mul_f32 v20, v44, v9
    v_mul_f32 v21, v44, v11
    v_fma_f32 v20, -v45, v11, v20
    v_fmac_f32 v21, v45, v9
    v_mfma_f32_32x32x16_bf16 v[64:79], a[144:147], v[240:243], v[64:79]
    ds_read_b64_tr_b16 a[132:133], v25 offset:2048
    ds_read_b64_tr_b16 a[134:135], v25 offset:2560
    buffer_load_dwordx4 v15, s[56:59], s83 offen offset:3072 lds
    v_accvgpr_read_b32 v2, a56
    ds_write_b64 v2, v[20:21]
    v_accvgpr_read_b32 v11, a57
    v_accvgpr_read_b32 v29, a54
    v_accvgpr_read_b32 v30, a55
    v_mov_b32 v39, s76
    v_mfma_f32_32x32x16_bf16 v[64:79], a[148:151], v[244:247], v[64:79]
    ds_read_b64_tr_b16 a[136:137], v25 offset:4096
    ds_read_b64_tr_b16 a[138:139], v25 offset:4608
    s_waitcnt lgkmcnt(2)
    s_barrier
    ds_read_b128 v[60:63], v3 offset:1328
    ds_read_b128 v[56:59], v3 offset:1312
    ds_read_b128 v[52:55], v3 offset:1296
    ds_read_b128 v[48:51], v3 offset:1280
    ds_read2_b64 v[80:83], v11 offset0:0 offset1:32
    ds_read2_b64 v[84:87], v11 offset0:64 offset1:96
    ds_read2_b64 v[88:91], v11 offset0:128 offset1:160
    ds_read2_b64 v[92:95], v11 offset0:192 offset1:224
    v_mfma_f32_32x32x16_bf16 v[64:79], a[152:155], v[248:251], v[64:79]
    ds_read_b64_tr_b16 a[140:141], v25 offset:6144
    ds_read_b64_tr_b16 a[142:143], v25 offset:6656
    v_mfma_f32_32x32x16_bf16 v[64:79], a[156:159], v[252:255], v[64:79]
    ds_read_b64_tr_b16 a[144:145], v25 offset:8192
    ds_read_b64_tr_b16 a[146:147], v25 offset:8704
    s_waitcnt lgkmcnt(7)
    v_pk_add_f32 v[80:81], v[80:81], v[82:83]
    s_waitcnt lgkmcnt(6)
    v_pk_add_f32 v[84:85], v[84:85], v[86:87]
    s_waitcnt lgkmcnt(5)
    v_pk_add_f32 v[88:89], v[88:89], v[90:91]
    s_waitcnt lgkmcnt(4)
    v_pk_add_f32 v[92:93], v[92:93], v[94:95]
    v_pk_add_f32 v[80:81], v[80:81], v[84:85]
    v_pk_add_f32 v[88:89], v[88:89], v[92:93]
    v_pk_add_f32 v[80:81], v[80:81], v[88:89]
    v_fma_f32 v42, v40, v80, v46
    v_fma_f32 v43, v40, v81, v47
    v_fma_f32 v42, -v41, v81, v42
    v_fmac_f32 v43, v41, v80
    v_pk_fma_f32 v[96:97], v[42:43], v[34:35], v[96:97] op_sel_hi:[1,0,1]
    v_pk_fma_f32 v[96:97], v[42:43], v[32:33], v[96:97] op_sel:[1,0,0] op_sel_hi:[0,1,1]
    v_pk_fma_f32 v[112:113], v[96:97], v[34:35], v[112:113] op_sel_hi:[1,0,1]
    v_pk_fma_f32 v[112:113], v[96:97], v[32:33], v[112:113] op_sel:[1,0,0] op_sel_hi:[0,1,1]
    v_pk_fma_f32 v[98:99], v[112:113], v[34:35], v[98:99] op_sel_hi:[1,0,1]
    v_pk_fma_f32 v[98:99], v[112:113], v[32:33], v[98:99] op_sel:[1,0,0] op_sel_hi:[0,1,1]
    v_cvt_pk_bf16_f32 v96, v96, v112
    v_cvt_pk_bf16_f32 v112, v97, v113
    v_pk_fma_f32 v[114:115], v[98:99], v[34:35], v[114:115] op_sel_hi:[1,0,1]
    v_pk_fma_f32 v[114:115], v[98:99], v[32:33], v[114:115] op_sel:[1,0,0] op_sel_hi:[0,1,1]
    v_pk_fma_f32 v[100:101], v[114:115], v[34:35], v[100:101] op_sel_hi:[1,0,1]
    v_pk_fma_f32 v[100:101], v[114:115], v[32:33], v[100:101] op_sel:[1,0,0] op_sel_hi:[0,1,1]
    v_cvt_pk_bf16_f32 v97, v98, v114
    v_cvt_pk_bf16_f32 v113, v99, v115
    v_pk_fma_f32 v[116:117], v[100:101], v[34:35], v[116:117] op_sel_hi:[1,0,1]
    v_pk_fma_f32 v[116:117], v[100:101], v[32:33], v[116:117] op_sel:[1,0,0] op_sel_hi:[0,1,1]
    v_pk_fma_f32 v[102:103], v[116:117], v[34:35], v[102:103] op_sel_hi:[1,0,1]
    v_pk_fma_f32 v[102:103], v[116:117], v[32:33], v[102:103] op_sel:[1,0,0] op_sel_hi:[0,1,1]
    v_cvt_pk_bf16_f32 v98, v100, v116
    v_cvt_pk_bf16_f32 v114, v101, v117
    v_pk_fma_f32 v[118:119], v[102:103], v[34:35], v[118:119] op_sel_hi:[1,0,1]
    v_pk_fma_f32 v[118:119], v[102:103], v[32:33], v[118:119] op_sel:[1,0,0] op_sel_hi:[0,1,1]
    v_pk_fma_f32 v[104:105], v[118:119], v[34:35], v[104:105] op_sel_hi:[1,0,1]
    v_pk_fma_f32 v[104:105], v[118:119], v[32:33], v[104:105] op_sel:[1,0,0] op_sel_hi:[0,1,1]
    v_cvt_pk_bf16_f32 v99, v102, v118
    v_cvt_pk_bf16_f32 v115, v103, v119
    v_pk_fma_f32 v[120:121], v[104:105], v[34:35], v[120:121] op_sel_hi:[1,0,1]
    v_pk_fma_f32 v[120:121], v[104:105], v[32:33], v[120:121] op_sel:[1,0,0] op_sel_hi:[0,1,1]
    v_pk_fma_f32 v[106:107], v[120:121], v[34:35], v[106:107] op_sel_hi:[1,0,1]
    v_pk_fma_f32 v[106:107], v[120:121], v[32:33], v[106:107] op_sel:[1,0,0] op_sel_hi:[0,1,1]
    v_cvt_pk_bf16_f32 v100, v104, v120
    v_cvt_pk_bf16_f32 v116, v105, v121
    v_pk_fma_f32 v[122:123], v[106:107], v[34:35], v[122:123] op_sel_hi:[1,0,1]
    v_pk_fma_f32 v[122:123], v[106:107], v[32:33], v[122:123] op_sel:[1,0,0] op_sel_hi:[0,1,1]
    v_pk_fma_f32 v[108:109], v[122:123], v[34:35], v[108:109] op_sel_hi:[1,0,1]
    v_pk_fma_f32 v[108:109], v[122:123], v[32:33], v[108:109] op_sel:[1,0,0] op_sel_hi:[0,1,1]
    v_cvt_pk_bf16_f32 v101, v106, v122
    v_cvt_pk_bf16_f32 v117, v107, v123
    v_pk_fma_f32 v[124:125], v[108:109], v[34:35], v[124:125] op_sel_hi:[1,0,1]
    v_pk_fma_f32 v[124:125], v[108:109], v[32:33], v[124:125] op_sel:[1,0,0] op_sel_hi:[0,1,1]
    s_waitcnt vmcnt(2)
    buffer_store_dword v39, v29, s[60:63], 0 offen offset:0 sc1
    v_pk_fma_f32 v[110:111], v[124:125], v[34:35], v[110:111] op_sel_hi:[1,0,1]
    v_pk_fma_f32 v[110:111], v[124:125], v[32:33], v[110:111] op_sel:[1,0,0] op_sel_hi:[0,1,1]
    v_cvt_pk_bf16_f32 v102, v108, v124
    v_cvt_pk_bf16_f32 v118, v109, v125
    v_pk_fma_f32 v[126:127], v[110:111], v[34:35], v[126:127] op_sel_hi:[1,0,1]
    v_pk_fma_f32 v[126:127], v[110:111], v[32:33], v[126:127] op_sel:[1,0,0] op_sel_hi:[0,1,1]
    v_pk_fma_f32 v[48:49], v[64:65], v[26:27], v[48:49] op_sel_hi:[1,0,1]
    v_pk_fma_f32 v[50:51], v[66:67], v[26:27], v[50:51] op_sel_hi:[1,0,1]
    v_pk_fma_f32 v[52:53], v[68:69], v[26:27], v[52:53] op_sel_hi:[1,0,1]
    v_pk_fma_f32 v[54:55], v[70:71], v[26:27], v[54:55] op_sel_hi:[1,0,1]
    v_accvgpr_read_b32 v8, a58
    v_accvgpr_read_b32 v44, a59
    v_accvgpr_read_b32 v4, a60
    v_xor_b32 v5, 16, v4
    v_xor_b32 v6, 32, v4
    v_xor_b32 v7, 48, v4
    v_cvt_pk_bf16_f32 v103, v110, v126
    v_cvt_pk_bf16_f32 v119, v111, v127
    v_mfma_f32_32x32x16_bf16 v[80:95], a[128:131], v[128:131], 0
    ds_read_b64_tr_b16 a[148:149], v25 offset:10240
    ds_read_b64_tr_b16 a[150:151], v25 offset:10752
    ds_write_b128 v8, v[96:99]
    v_exp_f32 v64, v48
    v_mfma_f32_32x32x16_bf16 v[80:95], a[132:135], v[132:135], v[80:95]
    ds_read_b64_tr_b16 a[152:153], v25 offset:12288
    ds_read_b64_tr_b16 a[154:155], v25 offset:12800
    ds_write_b128 v44, v[100:103]
    v_exp_f32 v65, v49
    v_mfma_f32_32x32x16_bf16 v[80:95], a[136:139], v[136:139], v[80:95]
    ds_read_b64_tr_b16 a[156:157], v25 offset:14336
    ds_read_b64_tr_b16 a[158:159], v25 offset:14848
    ds_read_b64_tr_b16 a[88:89], v4 offset:0
    ds_read_b64_tr_b16 a[90:91], v6 offset:256
    v_exp_f32 v66, v50
    s_waitcnt lgkmcnt(7)
    v_mfma_f32_32x32x16_bf16 v[80:95], a[140:143], v[140:143], v[80:95]
    ds_read_b64_tr_b16 a[128:129], v25 offset:16384
    ds_read_b64_tr_b16 a[130:131], v25 offset:16896
    ds_read_b64_tr_b16 a[92:93], v5 offset:0
    ds_read_b64_tr_b16 a[94:95], v7 offset:256
    v_exp_f32 v67, v51
    v_mfma_f32_32x32x16_bf16 v[80:95], a[144:147], v[144:147], v[80:95]
    ds_read_b64_tr_b16 a[132:133], v25 offset:18432
    ds_read_b64_tr_b16 a[134:135], v25 offset:18944
    ds_write_b128 v8, v[112:115]
    v_exp_f32 v68, v52
    v_mfma_f32_32x32x16_bf16 v[80:95], a[148:151], v[148:151], v[80:95]
    ds_read_b64_tr_b16 a[136:137], v25 offset:20480
    ds_read_b64_tr_b16 a[138:139], v25 offset:20992
    ds_write_b128 v44, v[116:119]
    s_waitcnt lgkmcnt(8)
    buffer_store_dwordx4 a[88:91], v28, s[60:63], s94 offen offset:0 sc1
    v_exp_f32 v69, v53
    v_mfma_f32_32x32x16_bf16 v[80:95], a[152:155], v[152:155], v[80:95]
    ds_read_b64_tr_b16 a[140:141], v25 offset:22528
    ds_read_b64_tr_b16 a[142:143], v25 offset:23040
    ds_read_b64_tr_b16 a[96:97], v4 offset:0
    ds_read_b64_tr_b16 a[98:99], v6 offset:256
    v_mfma_f32_32x32x16_bf16 v[80:95], a[156:159], v[156:159], v[80:95]
    ds_read_b64_tr_b16 a[144:145], v25 offset:24576
    ds_read_b64_tr_b16 a[146:147], v25 offset:25088
    ds_read_b64_tr_b16 a[100:101], v5 offset:0
    ds_read_b64_tr_b16 a[102:103], v7 offset:256
    s_waitcnt lgkmcnt(8)
    buffer_store_dwordx4 a[92:95], v28, s[60:63], s94 offen offset:1024 sc1
    v_exp_f32 v70, v54
    v_mfma_f32_32x32x16_bf16 v[80:95], a[128:131], v[160:163], v[80:95]
    ds_read_b64_tr_b16 a[148:149], v25 offset:26624
    ds_read_b64_tr_b16 a[150:151], v25 offset:27136
    s_barrier
    v_exp_f32 v71, v55
    v_pk_add_f32 v[64:65], v[64:65], 1.0 op_sel_hi:[1,0]
    v_pk_add_f32 v[66:67], v[66:67], 1.0 op_sel_hi:[1,0]
    v_pk_add_f32 v[68:69], v[68:69], 1.0 op_sel_hi:[1,0]
    v_pk_add_f32 v[70:71], v[70:71], 1.0 op_sel_hi:[1,0]
    v_pk_fma_f32 v[64:65], v[64:65], v[64:65], 1.0 op_sel_hi:[1,1,0]
    v_pk_fma_f32 v[66:67], v[66:67], v[66:67], 1.0 op_sel_hi:[1,1,0]
    v_pk_fma_f32 v[68:69], v[68:69], v[68:69], 1.0 op_sel_hi:[1,1,0]
    v_pk_fma_f32 v[70:71], v[70:71], v[70:71], 1.0 op_sel_hi:[1,1,0]
    v_pk_fma_f32 v[56:57], v[72:73], v[26:27], v[56:57] op_sel_hi:[1,0,1]
    v_pk_fma_f32 v[58:59], v[74:75], v[26:27], v[58:59] op_sel_hi:[1,0,1]
    v_pk_fma_f32 v[60:61], v[76:77], v[26:27], v[60:61] op_sel_hi:[1,0,1]
    v_pk_fma_f32 v[62:63], v[78:79], v[26:27], v[62:63] op_sel_hi:[1,0,1]
    v_mfma_f32_32x32x16_bf16 v[80:95], a[132:135], v[164:167], v[80:95]
    ds_read_b64_tr_b16 a[152:153], v25 offset:28672
    ds_read_b64_tr_b16 a[154:155], v25 offset:29184
    s_add_u32 m0, s82, 65536
    s_xor_b32 s83, s100, 3
    s_lshl_b32 s83, s83, 17
    s_add_u32 s83, s83, s96
    buffer_load_dwordx4 v12, s[56:59], s83 offen offset:0 lds
    s_waitcnt lgkmcnt(2)
    buffer_store_dwordx4 a[96:99], v28, s[60:63], s94 offen offset:2048 sc1
    v_mfma_f32_32x32x16_bf16 v[80:95], a[136:139], v[168:171], v[80:95]
    ds_read_b64_tr_b16 a[156:157], v25 offset:30720
    ds_read_b64_tr_b16 a[158:159], v25 offset:31232
    v_rcp_f32 v64, v64
    v_rcp_f32 v65, v65
    v_mfma_f32_32x32x16_bf16 v[80:95], a[140:143], v[172:175], v[80:95]
    ds_read_b64_tr_b16 a[128:129], v25 offset:32768
    ds_read_b64_tr_b16 a[130:131], v25 offset:33280
    buffer_load_dwordx4 v13, s[56:59], s83 offen offset:1024 lds
    buffer_store_dwordx4 a[100:103], v28, s[60:63], s94 offen offset:3072 sc1
    v_rcp_f32 v66, v66
    v_rcp_f32 v67, v67
    v_mfma_f32_32x32x16_bf16 v[80:95], a[144:147], v[176:179], v[80:95]
    ds_read_b64_tr_b16 a[132:133], v25 offset:34816
    ds_read_b64_tr_b16 a[134:135], v25 offset:35328
    buffer_load_dword v31, v30, s[60:63], 0 offen offset:0 sc1
    v_rcp_f32 v68, v68
    v_rcp_f32 v69, v69
    v_mfma_f32_32x32x16_bf16 v[80:95], a[148:151], v[180:183], v[80:95]
    ds_read_b64_tr_b16 a[136:137], v25 offset:36864
    ds_read_b64_tr_b16 a[138:139], v25 offset:37376
    buffer_load_dwordx4 v14, s[56:59], s83 offen offset:2048 lds
    v_rcp_f32 v70, v70
    v_rcp_f32 v71, v71
    s_waitcnt lgkmcnt(4)
    v_mfma_f32_32x32x16_bf16 v[80:95], a[152:155], v[184:187], v[80:95]
    ds_read_b64_tr_b16 a[140:141], v25 offset:38912
    ds_read_b64_tr_b16 a[142:143], v25 offset:39424
    v_exp_f32 v72, v56
    v_exp_f32 v73, v57
    v_exp_f32 v74, v58
    v_mfma_f32_32x32x16_bf16 v[80:95], a[156:159], v[188:191], v[80:95]
    ds_read_b64_tr_b16 a[144:145], v25 offset:40960
    ds_read_b64_tr_b16 a[146:147], v25 offset:41472
    buffer_load_dwordx4 v15, s[56:59], s83 offen offset:3072 lds
    v_exp_f32 v75, v59
    v_exp_f32 v76, v60
    v_mfma_f32_32x32x16_bf16 v[80:95], a[128:131], v[192:195], v[80:95]
    ds_read_b64_tr_b16 a[148:149], v25 offset:43008
    ds_read_b64_tr_b16 a[150:151], v25 offset:43520
    v_exp_f32 v77, v61
    v_exp_f32 v78, v62
    v_exp_f32 v79, v63
    v_pk_fma_f32 v[64:65], v[64:65], s[78:79], v[26:27] op_sel:[0,0,1] op_sel_hi:[1,0,1]
    v_pk_fma_f32 v[66:67], v[66:67], s[78:79], v[26:27] op_sel:[0,0,1] op_sel_hi:[1,0,1]
    v_pk_fma_f32 v[68:69], v[68:69], s[78:79], v[26:27] op_sel:[0,0,1] op_sel_hi:[1,0,1]
    v_pk_fma_f32 v[70:71], v[70:71], s[78:79], v[26:27] op_sel:[0,0,1] op_sel_hi:[1,0,1]
    v_pk_mul_f32 v[48:49], v[48:49], v[64:65]
    v_pk_mul_f32 v[50:51], v[50:51], v[66:67]
    v_pk_mul_f32 v[52:53], v[52:53], v[68:69]
    v_pk_mul_f32 v[54:55], v[54:55], v[70:71]
    v_pk_add_f32 v[72:73], v[72:73], 1.0 op_sel_hi:[1,0]
    v_pk_add_f32 v[74:75], v[74:75], 1.0 op_sel_hi:[1,0]
    v_pk_add_f32 v[76:77], v[76:77], 1.0 op_sel_hi:[1,0]
    v_pk_add_f32 v[78:79], v[78:79], 1.0 op_sel_hi:[1,0]
    v_pk_fma_f32 v[72:73], v[72:73], v[72:73], 1.0 op_sel_hi:[1,1,0]
    v_pk_fma_f32 v[74:75], v[74:75], v[74:75], 1.0 op_sel_hi:[1,1,0]
    v_pk_fma_f32 v[76:77], v[76:77], v[76:77], 1.0 op_sel_hi:[1,1,0]
    v_pk_fma_f32 v[78:79], v[78:79], v[78:79], 1.0 op_sel_hi:[1,1,0]
    s_waitcnt lgkmcnt(0)
    v_mfma_f32_32x32x16_bf16 v[80:95], a[132:135], v[196:199], v[80:95]
    ds_read_b64_tr_b16 a[152:153], v25 offset:45056
    ds_read_b64_tr_b16 a[154:155], v25 offset:45568
    s_barrier
    v_cvt_pk_bf16_f32 v64, v48, v49
    v_cvt_pk_bf16_f32 v65, v50, v51
    v_cvt_pk_bf16_f32 v66, v52, v53
    v_mfma_f32_32x32x16_bf16 v[80:95], a[136:139], v[200:203], v[80:95]
    ds_read_b64_tr_b16 a[156:157], v25 offset:47104
    ds_read_b64_tr_b16 a[158:159], v25 offset:47616
    s_add_u32 m0, s82, 81920
    s_xor_b32 s83, s95, 128
    buffer_load_dwordx4 v16, s[48:51], s83 offen offset:0 lds
    v_mfma_f32_32x32x16_bf16 v[80:95], a[140:143], v[204:207], v[80:95]
    ds_read_b64_tr_b16 a[128:129], v25 offset:49152
    ds_read_b64_tr_b16 a[130:131], v25 offset:49664
    v_cvt_pk_bf16_f32 v67, v54, v55
    v_rcp_f32 v72, v72
    v_mfma_f32_32x32x16_bf16 v[80:95], a[144:147], v[208:211], v[80:95]
    ds_read_b64_tr_b16 a[132:133], v25 offset:51200
    ds_read_b64_tr_b16 a[134:135], v25 offset:51712
    buffer_load_dwordx4 v17, s[48:51], s83 offen offset:1024 lds
    v_rcp_f32 v73, v73
    v_rcp_f32 v74, v74
    v_mfma_f32_32x32x16_bf16 v[80:95], a[148:151], v[212:215], v[80:95]
    ds_read_b64_tr_b16 a[136:137], v25 offset:53248
    ds_read_b64_tr_b16 a[138:139], v25 offset:53760
    v_rcp_f32 v75, v75
    v_rcp_f32 v76, v76
    s_waitcnt lgkmcnt(4)
    v_mfma_f32_32x32x16_bf16 v[80:95], a[152:155], v[216:219], v[80:95]
    ds_read_b64_tr_b16 a[140:141], v25 offset:55296
    ds_read_b64_tr_b16 a[142:143], v25 offset:55808
    buffer_load_dwordx4 v18, s[48:51], s83 offen offset:2048 lds
    v_rcp_f32 v77, v77
    v_mfma_f32_32x32x16_bf16 v[80:95], a[156:159], v[220:223], v[80:95]
    ds_read_b64_tr_b16 a[144:145], v25 offset:57344
    ds_read_b64_tr_b16 a[146:147], v25 offset:57856
    v_rcp_f32 v78, v78
    v_rcp_f32 v79, v79
    v_pk_fma_f32 v[72:73], v[72:73], s[78:79], v[26:27] op_sel:[0,0,1] op_sel_hi:[1,0,1]
    v_pk_fma_f32 v[74:75], v[74:75], s[78:79], v[26:27] op_sel:[0,0,1] op_sel_hi:[1,0,1]
    v_pk_fma_f32 v[76:77], v[76:77], s[78:79], v[26:27] op_sel:[0,0,1] op_sel_hi:[1,0,1]
    v_pk_fma_f32 v[78:79], v[78:79], s[78:79], v[26:27] op_sel:[0,0,1] op_sel_hi:[1,0,1]
    v_pk_mul_f32 v[56:57], v[56:57], v[72:73]
    v_pk_mul_f32 v[58:59], v[58:59], v[74:75]
    v_pk_mul_f32 v[60:61], v[60:61], v[76:77]
    v_pk_mul_f32 v[62:63], v[62:63], v[78:79]
    v_mfma_f32_32x32x16_bf16 v[80:95], a[128:131], v[224:227], v[80:95]
    ds_read_b64_tr_b16 a[148:149], v25 offset:59392
    ds_read_b64_tr_b16 a[150:151], v25 offset:59904
    buffer_load_dwordx4 v19, s[48:51], s83 offen offset:3072 lds
    s_barrier
    ds_read_b128 v[52:55], v3 offset:1424
    ds_read_b128 v[48:51], v3 offset:1408
    v_cvt_pk_bf16_f32 v68, v56, v57
    v_cvt_pk_bf16_f32 v69, v58, v59
    ds_read_b128 v[56:59], v3 offset:1440
    s_waitcnt lgkmcnt(5)
    v_mfma_f32_32x32x16_bf16 v[80:95], a[132:135], v[228:231], v[80:95]
    ds_read_b64_tr_b16 a[152:153], v25 offset:61440
    ds_read_b64_tr_b16 a[154:155], v25 offset:61952
    s_add_u32 m0, s82, 98304
    s_xor_b32 s83, s95, 128
    buffer_load_dwordx4 v16, s[52:55], s83 offen offset:0 lds
    v_cvt_pk_bf16_f32 v70, v60, v61
    v_cvt_pk_bf16_f32 v71, v62, v63
    ds_read_b128 v[60:63], v3 offset:1456
    v_mfma_f32_32x32x16_bf16 v[80:95], a[136:139], v[232:235], v[80:95]
    ds_read_b64_tr_b16 a[156:157], v25 offset:63488
    ds_read_b64_tr_b16 a[158:159], v25 offset:64000
    v_permlane16_swap_b32 v64, v68
    v_mfma_f32_32x32x16_bf16 v[80:95], a[140:143], v[236:239], v[80:95]
    buffer_load_dwordx4 v17, s[52:55], s83 offen offset:1024 lds
    v_permlane16_swap_b32 v65, v69
    v_permlane16_swap_b32 v66, v70
    v_permlane16_swap_b32 v67, v71
    buffer_store_dwordx4 v[64:67], v28, s[60:63], s92 offen offset:0 sc1
    v_accvgpr_write_b32 a80, v64
    v_accvgpr_write_b32 a81, v65
    v_accvgpr_write_b32 a82, v66
    v_mfma_f32_32x32x16_bf16 v[80:95], a[144:147], v[240:243], v[80:95]
    v_accvgpr_write_b32 a83, v67
    buffer_store_dwordx4 v[68:71], v28, s[60:63], s92 offen offset:1024 sc1
    v_accvgpr_write_b32 a84, v68
    v_accvgpr_write_b32 a85, v69
    v_accvgpr_write_b32 a86, v70
    v_accvgpr_write_b32 a87, v71
    v_accvgpr_read_b32 v32, a63
    s_waitcnt lgkmcnt(0)
    v_mfma_f32_32x32x16_bf16 v[80:95], a[148:151], v[244:247], v[80:95]
    buffer_load_dwordx4 v18, s[52:55], s83 offen offset:2048 lds
    v_accvgpr_read_b32 v36, a247
    v_accvgpr_read_b32 v10, a62
    v_xor_b32 v33, 32, v32
    v_xor_b32 v34, 64, v32
    v_xor_b32 v35, 96, v32
    v_xor_b32 v37, 64, v36
    v_mfma_f32_32x32x16_bf16 v[80:95], a[152:155], v[248:251], v[80:95]
    v_mfma_f32_32x32x16_bf16 v[80:95], a[156:159], v[252:255], v[80:95]
    buffer_load_dwordx4 v19, s[52:55], s83 offen offset:3072 lds
    s_nop 10
    v_pk_fma_f32 v[48:49], v[80:81], v[26:27], v[48:49] op_sel_hi:[1,0,1]
    v_pk_fma_f32 v[50:51], v[82:83], v[26:27], v[50:51] op_sel_hi:[1,0,1]
    v_pk_fma_f32 v[52:53], v[84:85], v[26:27], v[52:53] op_sel_hi:[1,0,1]
    v_pk_fma_f32 v[54:55], v[86:87], v[26:27], v[54:55] op_sel_hi:[1,0,1]
    v_exp_f32 v80, v48
    v_exp_f32 v81, v49
    v_exp_f32 v82, v50
    v_exp_f32 v83, v51
    v_exp_f32 v84, v52
    v_exp_f32 v85, v53
    v_exp_f32 v86, v54
    v_exp_f32 v87, v55
    v_pk_add_f32 v[80:81], v[80:81], 1.0 op_sel_hi:[1,0]
    v_pk_add_f32 v[82:83], v[82:83], 1.0 op_sel_hi:[1,0]
    v_pk_add_f32 v[84:85], v[84:85], 1.0 op_sel_hi:[1,0]
    v_pk_add_f32 v[86:87], v[86:87], 1.0 op_sel_hi:[1,0]
    v_pk_fma_f32 v[80:81], v[80:81], v[80:81], 1.0 op_sel_hi:[1,1,0]
    v_pk_fma_f32 v[82:83], v[82:83], v[82:83], 1.0 op_sel_hi:[1,1,0]
    v_pk_fma_f32 v[84:85], v[84:85], v[84:85], 1.0 op_sel_hi:[1,1,0]
    v_pk_fma_f32 v[86:87], v[86:87], v[86:87], 1.0 op_sel_hi:[1,1,0]
    v_rcp_f32 v80, v80
    v_rcp_f32 v81, v81
    v_rcp_f32 v82, v82
    v_rcp_f32 v83, v83
    s_waitcnt vmcnt(13)
    buffer_store_dword v39, v29, s[60:63], 0 offen offset:128 sc1
    s_waitcnt vmcnt(13)
    v_cmp_ne_u32 vcc, s76, v31
    s_cbranch_vccnz L_retry_fa
L_back_fa:
    v_rcp_f32 v84, v84
    buffer_load_dwordx4 v[192:195], v28, s[60:63], s8 offen offset:0 sc1
    v_rcp_f32 v85, v85
    buffer_load_dwordx4 v[196:199], v28, s[60:63], s8 offen offset:1024 sc1
    v_rcp_f32 v86, v86
    buffer_load_dwordx4 v[200:203], v28, s[60:63], s8 offen offset:2048 sc1
    v_rcp_f32 v87, v87
    buffer_load_dwordx4 v[204:207], v28, s[60:63], s8 offen offset:3072 sc1
    v_pk_fma_f32 v[80:81], v[80:81], s[78:79], v[26:27] op_sel:[0,0,1] op_sel_hi:[1,0,1]
    v_pk_fma_f32 v[82:83], v[82:83], s[78:79], v[26:27] op_sel:[0,0,1] op_sel_hi:[1,0,1]
    v_pk_fma_f32 v[84:85], v[84:85], s[78:79], v[26:27] op_sel:[0,0,1] op_sel_hi:[1,0,1]
    buffer_load_dwordx4 v[208:211], v28, s[60:63], s9 offen offset:0 sc1
    v_pk_fma_f32 v[86:87], v[86:87], s[78:79], v[26:27] op_sel:[0,0,1] op_sel_hi:[1,0,1]
    v_pk_mul_f32 v[48:49], v[48:49], v[80:81]
    buffer_load_dwordx4 v[212:215], v28, s[60:63], s9 offen offset:1024 sc1
    v_pk_mul_f32 v[50:51], v[50:51], v[82:83]
    v_pk_mul_f32 v[52:53], v[52:53], v[84:85]
    v_pk_mul_f32 v[54:55], v[54:55], v[86:87]
    buffer_load_dwordx4 v[216:219], v28, s[60:63], s9 offen offset:2048 sc1
    v_cvt_pk_bf16_f32 v80, v48, v49
    v_cvt_pk_bf16_f32 v81, v50, v51
    buffer_load_dwordx4 v[220:223], v28, s[60:63], s9 offen offset:3072 sc1
    v_cvt_pk_bf16_f32 v82, v52, v53
    v_cvt_pk_bf16_f32 v83, v54, v55
    v_pk_fma_f32 v[56:57], v[88:89], v[26:27], v[56:57] op_sel_hi:[1,0,1]
    v_add_u32 v22, 81920, v34
    v_pk_fma_f32 v[58:59], v[90:91], v[26:27], v[58:59] op_sel_hi:[1,0,1]
    v_pk_fma_f32 v[60:61], v[92:93], v[26:27], v[60:61] op_sel_hi:[1,0,1]
    ds_read_b64_tr_b16 a[0:1], v22 offset:49152
    v_pk_fma_f32 v[62:63], v[94:95], v[26:27], v[62:63] op_sel_hi:[1,0,1]
    v_exp_f32 v88, v56
    ds_read_b64_tr_b16 a[2:3], v22 offset:50176
    v_exp_f32 v89, v57
    v_add_u32 v20, 81920, v32
    v_exp_f32 v90, v58
    v_exp_f32 v91, v59
    ds_read_b64_tr_b16 a[4:5], v20 offset:53248
    v_exp_f32 v92, v60
    ds_read_b64_tr_b16 a[6:7], v20 offset:54272
    v_exp_f32 v93, v61
    ds_read_b64_tr_b16 a[8:9], v22 offset:53248
    v_exp_f32 v94, v62
    v_exp_f32 v95, v63
    ds_read_b64_tr_b16 a[10:11], v22 offset:54272
    v_pk_add_f32 v[88:89], v[88:89], 1.0 op_sel_hi:[1,0]
    ds_read_b64_tr_b16 a[12:13], v20 offset:49152
    v_pk_add_f32 v[90:91], v[90:91], 1.0 op_sel_hi:[1,0]
    v_pk_add_f32 v[92:93], v[92:93], 1.0 op_sel_hi:[1,0]
    v_pk_add_f32 v[94:95], v[94:95], 1.0 op_sel_hi:[1,0]
    ds_read_b64_tr_b16 a[14:15], v20 offset:50176
    v_pk_fma_f32 v[88:89], v[88:89], v[88:89], 1.0 op_sel_hi:[1,1,0]
    v_pk_fma_f32 v[90:91], v[90:91], v[90:91], 1.0 op_sel_hi:[1,1,0]
    v_pk_fma_f32 v[92:93], v[92:93], v[92:93], 1.0 op_sel_hi:[1,1,0]
    v_add_u32 v23, 81920, v35
    v_pk_fma_f32 v[94:95], v[94:95], v[94:95], 1.0 op_sel_hi:[1,1,0]
    v_rcp_f32 v88, v88
    ds_read_b64_tr_b16 a[16:17], v23 offset:49152
    v_rcp_f32 v89, v89
    ds_read_b64_tr_b16 a[18:19], v23 offset:50176
    v_rcp_f32 v90, v90
    v_add_u32 v21, 81920, v33
    v_rcp_f32 v91, v91
    v_rcp_f32 v92, v92
    ds_read_b64_tr_b16 a[20:21], v21 offset:53248
    v_rcp_f32 v93, v93
    ds_read_b64_tr_b16 a[22:23], v21 offset:54272
    v_rcp_f32 v94, v94
    ds_read_b64_tr_b16 a[24:25], v23 offset:53248
    v_rcp_f32 v95, v95
    v_pk_fma_f32 v[88:89], v[88:89], s[78:79], v[26:27] op_sel:[0,0,1] op_sel_hi:[1,0,1]
    ds_read_b64_tr_b16 a[26:27], v23 offset:54272
    v_pk_fma_f32 v[90:91], v[90:91], s[78:79], v[26:27] op_sel:[0,0,1] op_sel_hi:[1,0,1]
    v_pk_fma_f32 v[92:93], v[92:93], s[78:79], v[26:27] op_sel:[0,0,1] op_sel_hi:[1,0,1]
    ds_read_b64_tr_b16 a[28:29], v21 offset:49152
    v_pk_fma_f32 v[94:95], v[94:95], s[78:79], v[26:27] op_sel:[0,0,1] op_sel_hi:[1,0,1]
    v_pk_mul_f32 v[56:57], v[56:57], v[88:89]
    v_pk_mul_f32 v[58:59], v[58:59], v[90:91]
    ds_read_b64_tr_b16 a[30:31], v21 offset:50176
    v_pk_mul_f32 v[60:61], v[60:61], v[92:93]
    v_pk_mul_f32 v[62:63], v[62:63], v[94:95]
    v_cvt_pk_bf16_f32 v84, v56, v57
    v_cvt_pk_bf16_f32 v85, v58, v59
    v_cvt_pk_bf16_f32 v86, v60, v61
    v_cvt_pk_bf16_f32 v87, v62, v63
    v_permlane16_swap_b32 v80, v84
    v_permlane16_swap_b32 v81, v85
    v_permlane16_swap_b32 v82, v86
    v_permlane16_swap_b32 v83, v87
    buffer_store_dwordx4 v[80:83], v10, s[60:63], s93 offen offset:0 sc1
    buffer_store_dwordx4 v[84:87], v10, s[60:63], s93 offen offset:1024 sc1
    s_waitcnt lgkmcnt(1)
    v_mfma_f32_16x16x32_bf16 v[144:147], a[64:67], a[0:3], 0
    v_mfma_f32_16x16x32_bf16 v[152:155], a[68:71], a[0:3], 0
    v_mfma_f32_16x16x32_bf16 v[160:163], a[64:67], a[4:7], 0
    ds_read_b64_tr_b16 a[32:33], v22 offset:57344
    ds_read_b64_tr_b16 a[34:35], v22 offset:58368
    v_mfma_f32_16x16x32_bf16 v[168:171], a[68:71], a[4:7], 0
    v_mfma_f32_16x16x32_bf16 v[176:179], a[64:67], a[8:11], 0
    ds_read_b64_tr_b16 a[36:37], v20 offset:61440
    ds_read_b64_tr_b16 a[38:39], v20 offset:62464
    v_mfma_f32_16x16x32_bf16 v[184:187], a[68:71], a[8:11], 0
    v_mfma_f32_16x16x32_bf16 v[128:131], a[64:67], a[12:15], 0
    ds_read_b64_tr_b16 a[40:41], v22 offset:61440
    ds_read_b64_tr_b16 a[42:43], v22 offset:62464
    v_mfma_f32_16x16x32_bf16 v[136:139], a[68:71], a[12:15], 0
    v_mfma_f32_16x16x32_bf16 v[148:151], a[64:67], a[16:19], 0
    ds_read_b64_tr_b16 a[44:45], v20 offset:57344
    ds_read_b64_tr_b16 a[46:47], v20 offset:58368
    v_mfma_f32_16x16x32_bf16 v[156:159], a[68:71], a[16:19], 0
    v_mfma_f32_16x16x32_bf16 v[164:167], a[64:67], a[20:23], 0
    ds_read_b64_tr_b16 a[0:1], v23 offset:57344
    ds_read_b64_tr_b16 a[2:3], v23 offset:58368
    v_mfma_f32_16x16x32_bf16 v[172:175], a[68:71], a[20:23], 0
    v_mfma_f32_16x16x32_bf16 v[180:183], a[64:67], a[24:27], 0
    ds_read_b64_tr_b16 a[4:5], v21 offset:61440
    ds_read_b64_tr_b16 a[6:7], v21 offset:62464
    v_mfma_f32_16x16x32_bf16 v[188:191], a[68:71], a[24:27], 0
    s_waitcnt lgkmcnt(6)
    v_mfma_f32_16x16x32_bf16 v[132:135], a[64:67], a[28:31], 0
    ds_read_b64_tr_b16 a[8:9], v23 offset:61440
    ds_read_b64_tr_b16 a[10:11], v23 offset:62464
    v_mfma_f32_16x16x32_bf16 v[140:143], a[68:71], a[28:31], 0
    v_mfma_f32_16x16x32_bf16 v[144:147], a[72:75], a[32:35], v[144:147]
    ds_read_b64_tr_b16 a[12:13], v21 offset:57344
    ds_read_b64_tr_b16 a[14:15], v21 offset:58368
    v_mfma_f32_16x16x32_bf16 v[152:155], a[76:79], a[32:35], v[152:155]
    buffer_load_dwordx4 v[224:227], v28, s[60:63], s10 offen offset:0 sc1
    v_mfma_f32_16x16x32_bf16 v[160:163], a[72:75], a[36:39], v[160:163]
    ds_read_b128 a[16:19], v36 offset:4096
    v_mfma_f32_16x16x32_bf16 v[168:171], a[76:79], a[36:39], v[168:171]
    buffer_load_dwordx4 v[228:231], v28, s[60:63], s10 offen offset:1024 sc1
    v_mfma_f32_16x16x32_bf16 v[176:179], a[72:75], a[40:43], v[176:179]
    ds_read_b128 a[20:23], v36 offset:8192
    v_mfma_f32_16x16x32_bf16 v[184:187], a[76:79], a[40:43], v[184:187]
    s_waitcnt lgkmcnt(4)
    v_mfma_f32_16x16x32_bf16 v[128:131], a[72:75], a[44:47], v[128:131]
    ds_read_b128 a[24:27], v36 offset:12288
    v_mfma_f32_16x16x32_bf16 v[136:139], a[76:79], a[44:47], v[136:139]
    buffer_load_dwordx4 v[232:235], v28, s[60:63], s10 offen offset:2048 sc1
    v_mfma_f32_16x16x32_bf16 v[148:151], a[72:75], a[0:3], v[148:151]
    ds_read_b128 a[28:31], v36 offset:6144
    v_mfma_f32_16x16x32_bf16 v[156:159], a[76:79], a[0:3], v[156:159]
    buffer_load_dword v31, v30, s[60:63], 0 offen offset:128 sc1
    buffer_load_dwordx4 v[236:239], v28, s[60:63], s10 offen offset:3072 sc1
    v_mfma_f32_16x16x32_bf16 v[164:167], a[72:75], a[4:7], v[164:167]
    ds_read_b128 a[32:35], v36 offset:10240
    v_mfma_f32_16x16x32_bf16 v[172:175], a[76:79], a[4:7], v[172:175]
    v_mfma_f32_16x16x32_bf16 v[180:183], a[72:75], a[8:11], v[180:183]
    ds_read_b128 a[36:39], v36 offset:14336
    v_mfma_f32_16x16x32_bf16 v[188:191], a[76:79], a[8:11], v[188:191]
    s_waitcnt lgkmcnt(3)
    v_mfma_f32_16x16x32_bf16 v[132:135], a[72:75], a[12:15], v[132:135]
    ds_read_b128 a[40:43], v36 offset:20480
    v_mfma_f32_16x16x32_bf16 v[140:143], a[76:79], a[12:15], v[140:143]
    v_mfma_f32_16x16x32_bf16 v[144:147], a[88:91], a[16:19], v[144:147]
    ds_read_b128 a[44:47], v36 offset:24576
    v_mfma_f32_16x16x32_bf16 v[152:155], a[92:95], a[16:19], v[152:155]
    v_mfma_f32_16x16x32_bf16 v[160:163], a[88:91], a[20:23], v[160:163]
    ds_read_b128 a[0:3], v36 offset:28672
    v_mfma_f32_16x16x32_bf16 v[168:171], a[92:95], a[20:23], v[168:171]
    v_mfma_f32_16x16x32_bf16 v[176:179], a[88:91], a[24:27], v[176:179]
    ds_read_b128 a[4:7], v36 offset:22528
    v_mfma_f32_16x16x32_bf16 v[184:187], a[92:95], a[24:27], v[184:187]
    s_barrier
    s_waitcnt lgkmcnt(3)
    v_mfma_f32_16x16x32_bf16 v[148:151], a[88:91], a[28:31], v[148:151]
    ds_read_b128 a[8:11], v36 offset:26624
    v_mfma_f32_16x16x32_bf16 v[156:159], a[92:95], a[28:31], v[156:159]
    s_add_u32 m0, s82, 114688
    s_lshl_b32 s83, s24, 16
    s_add_u32 s83, s83, s96
    s_xor_b32 s83, s83, s31
    buffer_load_dwordx4 v12, s[56:59], s83 offen offset:0 lds
    v_mfma_f32_16x16x32_bf16 v[164:167], a[88:91], a[32:35], v[164:167]
    ds_read_b128 a[12:15], v36 offset:30720
    v_mfma_f32_16x16x32_bf16 v[172:175], a[92:95], a[32:35], v[172:175]
    buffer_load_dwordx4 v13, s[56:59], s83 offen offset:1024 lds
    v_mfma_f32_16x16x32_bf16 v[180:183], a[88:91], a[36:39], v[180:183]
    ds_read_b64_tr_b16 a[16:17], v34 offset:32768
    ds_read_b64_tr_b16 a[18:19], v34 offset:33792
    v_mfma_f32_16x16x32_bf16 v[188:191], a[92:95], a[36:39], v[188:191]
    v_mfma_f32_16x16x32_bf16 v[144:147], a[96:99], a[40:43], v[144:147]
    ds_read_b64_tr_b16 a[20:21], v32 offset:36864
    ds_read_b64_tr_b16 a[22:23], v32 offset:37888
    v_mfma_f32_16x16x32_bf16 v[152:155], a[100:103], a[40:43], v[152:155]
    buffer_load_dwordx4 v14, s[56:59], s83 offen offset:2048 lds
    s_waitcnt lgkmcnt(4)
    v_mfma_f32_16x16x32_bf16 v[160:163], a[96:99], a[44:47], v[160:163]
    ds_read_b64_tr_b16 a[24:25], v34 offset:36864
    ds_read_b64_tr_b16 a[26:27], v34 offset:37888
    ds_read_b64_tr_b16 a[128:129], v32 offset:32768
    ds_read_b64_tr_b16 a[130:131], v32 offset:33792
    v_mfma_f32_16x16x32_bf16 v[168:171], a[100:103], a[44:47], v[168:171]
    buffer_load_dwordx4 v15, s[56:59], s83 offen offset:3072 lds
    v_mfma_f32_16x16x32_bf16 v[176:179], a[96:99], a[0:3], v[176:179]
    ds_read_b64_tr_b16 a[28:29], v35 offset:32768
    ds_read_b64_tr_b16 a[30:31], v35 offset:33792
    v_mfma_f32_16x16x32_bf16 v[184:187], a[100:103], a[0:3], v[184:187]
    v_mfma_f32_16x16x32_bf16 v[148:151], a[96:99], a[4:7], v[148:151]
    ds_read_b64_tr_b16 a[32:33], v33 offset:36864
    ds_read_b64_tr_b16 a[34:35], v33 offset:37888
    v_mfma_f32_16x16x32_bf16 v[156:159], a[100:103], a[4:7], v[156:159]
    s_add_u32 m0, s82, 131072
    s_lshl_b32 s83, s25, 16
    s_add_u32 s83, s83, s96
    buffer_load_dwordx4 v12, s[56:59], s83 offen offset:0 lds
    v_mfma_f32_16x16x32_bf16 v[164:167], a[96:99], a[8:11], v[164:167]
    ds_read_b64_tr_b16 a[36:37], v35 offset:36864
    ds_read_b64_tr_b16 a[38:39], v35 offset:37888
    ds_read_b64_tr_b16 a[132:133], v33 offset:32768
    ds_read_b64_tr_b16 a[134:135], v33 offset:33792
    v_mfma_f32_16x16x32_bf16 v[172:175], a[100:103], a[8:11], v[172:175]
    v_mfma_f32_16x16x32_bf16 v[180:183], a[96:99], a[12:15], v[180:183]
    ds_read_b64_tr_b16 a[40:41], v34 offset:40960
    ds_read_b64_tr_b16 a[42:43], v34 offset:41984
    v_mfma_f32_16x16x32_bf16 v[188:191], a[100:103], a[12:15], v[188:191]
    buffer_load_dwordx4 v13, s[56:59], s83 offen offset:1024 lds
    s_waitcnt vmcnt(20) lgkmcnt(6)
    v_mfma_f32_16x16x32_bf16 v[144:147], v[192:195], a[16:19], v[144:147]
    ds_read_b64_tr_b16 a[44:45], v32 offset:45056
    ds_read_b64_tr_b16 a[46:47], v32 offset:46080
    s_waitcnt vmcnt(19)
    v_mfma_f32_16x16x32_bf16 v[152:155], v[196:199], a[16:19], v[152:155]
    s_waitcnt vmcnt(11)
    buffer_store_dword v39, v29, s[60:63], 0 offen offset:256 sc1
    buffer_load_dwordx4 v14, s[56:59], s83 offen offset:2048 lds
    v_mfma_f32_16x16x32_bf16 v[160:163], v[192:195], a[20:23], v[160:163]
    ds_read_b64_tr_b16 a[0:1], v34 offset:45056
    ds_read_b64_tr_b16 a[2:3], v34 offset:46080
    ds_read_b64_tr_b16 a[136:137], v32 offset:40960
    ds_read_b64_tr_b16 a[138:139], v32 offset:41984
    v_mfma_f32_16x16x32_bf16 v[168:171], v[196:199], a[20:23], v[168:171]
    v_mfma_f32_16x16x32_bf16 v[176:179], v[192:195], a[24:27], v[176:179]
    ds_read_b64_tr_b16 a[4:5], v35 offset:40960
    ds_read_b64_tr_b16 a[6:7], v35 offset:41984
    v_mfma_f32_16x16x32_bf16 v[184:187], v[196:199], a[24:27], v[184:187]
    buffer_load_dwordx4 v15, s[56:59], s83 offen offset:3072 lds
    v_mfma_f32_16x16x32_bf16 v[148:151], v[192:195], a[28:31], v[148:151]
    ds_read_b64_tr_b16 a[8:9], v33 offset:45056
    ds_read_b64_tr_b16 a[10:11], v33 offset:46080
    v_mfma_f32_16x16x32_bf16 v[156:159], v[196:199], a[28:31], v[156:159]
    v_mfma_f32_16x16x32_bf16 v[164:167], v[192:195], a[32:35], v[164:167]
    ds_read_b64_tr_b16 a[12:13], v35 offset:45056
    ds_read_b64_tr_b16 a[14:15], v35 offset:46080
    ds_read_b64_tr_b16 a[140:141], v33 offset:40960
    ds_read_b64_tr_b16 a[142:143], v33 offset:41984
    v_mfma_f32_16x16x32_bf16 v[172:175], v[196:199], a[32:35], v[172:175]
    s_waitcnt vmcnt(10)
    v_cmp_ne_u32 vcc, s76, v31
    s_cbranch_vccnz L_retry_fh
L_back_fh:
    buffer_load_dwordx4 v[240:243], v28, s[60:63], s11 offen offset:0 sc1
    s_waitcnt lgkmcnt(6)
    v_mfma_f32_16x16x32_bf16 v[180:183], v[192:195], a[36:39], v[180:183]
    ds_read_b64_tr_b16 a[16:17], v34 offset:49152
    ds_read_b64_tr_b16 a[18:19], v34 offset:50176
    v_mfma_f32_16x16x32_bf16 v[188:191], v[196:199], a[36:39], v[188:191]
    buffer_load_dwordx4 v[244:247], v28, s[60:63], s11 offen offset:1024 sc1
    v_mfma_f32_16x16x32_bf16 v[144:147], v[200:203], a[40:43], v[144:147]
    ds_read_b64_tr_b16 a[20:21], v32 offset:53248
    ds_read_b64_tr_b16 a[22:23], v32 offset:54272
    v_mfma_f32_16x16x32_bf16 v[152:155], v[204:207], a[40:43], v[152:155]
    v_mfma_f32_16x16x32_bf16 v[160:163], v[200:203], a[44:47], v[160:163]
    ds_read_b64_tr_b16 a[24:25], v35 offset:49152
    ds_read_b64_tr_b16 a[26:27], v35 offset:50176
    v_mfma_f32_16x16x32_bf16 v[168:171], v[204:207], a[44:47], v[168:171]
    buffer_load_dwordx4 v[248:251], v28, s[60:63], s11 offen offset:2048 sc1
    v_mfma_f32_16x16x32_bf16 v[176:179], v[200:203], a[0:3], v[176:179]
    ds_read_b64_tr_b16 a[28:29], v33 offset:53248
    ds_read_b64_tr_b16 a[30:31], v33 offset:54272
    v_mfma_f32_16x16x32_bf16 v[184:187], v[204:207], a[0:3], v[184:187]
    buffer_load_dwordx4 v[252:255], v28, s[60:63], s11 offen offset:3072 sc1
    v_mfma_f32_16x16x32_bf16 v[148:151], v[200:203], a[4:7], v[148:151]
    ds_read_b64_tr_b16 a[32:33], v34 offset:57344
    ds_read_b64_tr_b16 a[34:35], v34 offset:58368
    v_mfma_f32_16x16x32_bf16 v[156:159], v[204:207], a[4:7], v[156:159]
    s_waitcnt lgkmcnt(4)
    v_mfma_f32_16x16x32_bf16 v[164:167], v[200:203], a[8:11], v[164:167]
    ds_read_b64_tr_b16 a[36:37], v32 offset:61440
    ds_read_b64_tr_b16 a[38:39], v32 offset:62464
    v_mfma_f32_16x16x32_bf16 v[172:175], v[204:207], a[8:11], v[172:175]
    buffer_load_dwordx4 v[96:99], v28, s[60:63], s12 offen offset:0 sc1
    v_mfma_f32_16x16x32_bf16 v[180:183], v[200:203], a[12:15], v[180:183]
    ds_read_b64_tr_b16 a[40:41], v35 offset:57344
    ds_read_b64_tr_b16 a[42:43], v35 offset:58368
    v_mfma_f32_16x16x32_bf16 v[188:191], v[204:207], a[12:15], v[188:191]
    v_mfma_f32_16x16x32_bf16 v[144:147], v[208:211], a[16:19], v[144:147]
    ds_read_b64_tr_b16 a[44:45], v33 offset:61440
    ds_read_b64_tr_b16 a[46:47], v33 offset:62464
    v_mfma_f32_16x16x32_bf16 v[152:155], v[212:215], a[16:19], v[152:155]
    s_barrier
    buffer_load_dwordx4 v[100:103], v28, s[60:63], s12 offen offset:1024 sc1
    v_mfma_f32_16x16x32_bf16 v[160:163], v[208:211], a[20:23], v[160:163]
    v_add_u32 v22, 65536, v34
    ds_read_b64_tr_b16 a[0:1], v22 offset:0
    ds_read_b64_tr_b16 a[2:3], v22 offset:1024
    v_mfma_f32_16x16x32_bf16 v[168:171], v[212:215], a[20:23], v[168:171]
    buffer_load_dwordx4 v[104:107], v28, s[60:63], s13 offen offset:0 sc1
    v_mfma_f32_16x16x32_bf16 v[148:151], v[208:211], a[24:27], v[148:151]
    v_add_u32 v20, 65536, v32
    ds_read_b64_tr_b16 a[4:5], v20 offset:4096
    ds_read_b64_tr_b16 a[6:7], v20 offset:5120
    v_mfma_f32_16x16x32_bf16 v[156:159], v[212:215], a[24:27], v[156:159]
    s_waitcnt lgkmcnt(4)
    v_mfma_f32_16x16x32_bf16 v[164:167], v[208:211], a[28:31], v[164:167]
    v_add_u32 v23, 65536, v35
    ds_read_b64_tr_b16 a[8:9], v23 offset:0
    ds_read_b64_tr_b16 a[10:11], v23 offset:1024
    v_mfma_f32_16x16x32_bf16 v[172:175], v[212:215], a[28:31], v[172:175]
    buffer_load_dwordx4 v[108:111], v28, s[60:63], s13 offen offset:1024 sc1
    v_mfma_f32_16x16x32_bf16 v[144:147], v[216:219], a[32:35], v[144:147]
    v_add_u32 v21, 65536, v33
    ds_read_b64_tr_b16 a[12:13], v21 offset:4096
    ds_read_b64_tr_b16 a[14:15], v21 offset:5120
    v_mfma_f32_16x16x32_bf16 v[152:155], v[220:223], a[32:35], v[152:155]
    buffer_load_dwordx4 v[112:115], v28, s[60:63], s12 offen offset:2048 sc1
    v_mfma_f32_16x16x32_bf16 v[160:163], v[216:219], a[36:39], v[160:163]
    ds_read_b64_tr_b16 a[16:17], v22 offset:8192
    ds_read_b64_tr_b16 a[18:19], v22 offset:9216
    v_mfma_f32_16x16x32_bf16 v[168:171], v[220:223], a[36:39], v[168:171]
    v_mfma_f32_16x16x32_bf16 v[148:151], v[216:219], a[40:43], v[148:151]
    ds_read_b64_tr_b16 a[20:21], v20 offset:12288
    ds_read_b64_tr_b16 a[22:23], v20 offset:13312
    v_mfma_f32_16x16x32_bf16 v[156:159], v[220:223], a[40:43], v[156:159]
    buffer_load_dwordx4 v[116:119], v28, s[60:63], s12 offen offset:3072 sc1
    v_mfma_f32_16x16x32_bf16 v[164:167], v[216:219], a[44:47], v[164:167]
    ds_read_b64_tr_b16 a[24:25], v23 offset:8192
    ds_read_b64_tr_b16 a[26:27], v23 offset:9216
    v_mfma_f32_16x16x32_bf16 v[172:175], v[220:223], a[44:47], v[172:175]
    s_waitcnt lgkmcnt(5)
    v_mfma_f32_16x16x32_bf16 v[144:147], v[224:227], a[0:3], v[144:147]
    ds_read_b64_tr_b16 a[28:29], v21 offset:12288
    ds_read_b64_tr_b16 a[30:31], v21 offset:13312
    v_mfma_f32_16x16x32_bf16 v[152:155], v[228:231], a[0:3], v[152:155]
    buffer_load_dwordx4 v[120:123], v28, s[60:63], s13 offen offset:2048 sc1
    v_mfma_f32_16x16x32_bf16 v[160:163], v[224:227], a[4:7], v[160:163]
    ds_read_b128 a[32:35], v37 offset:4096
    v_mfma_f32_16x16x32_bf16 v[168:171], v[228:231], a[4:7], v[168:171]
    buffer_load_dwordx4 v[124:127], v28, s[60:63], s13 offen offset:3072 sc1
    v_mfma_f32_16x16x32_bf16 v[148:151], v[224:227], a[8:11], v[148:151]
    ds_read_b128 a[36:39], v37 offset:8192
    v_mfma_f32_16x16x32_bf16 v[156:159], v[228:231], a[8:11], v[156:159]
    buffer_load_dword v31, v30, s[60:63], 0 offen offset:256 sc1
    v_mfma_f32_16x16x32_bf16 v[164:167], v[224:227], a[12:15], v[164:167]
    ds_read_b128 a[40:43], v37 offset:6144
    v_mfma_f32_16x16x32_bf16 v[172:175], v[228:231], a[12:15], v[172:175]
    s_add_u32 m0, s82, 32768
    s_lshl_b32 s83, s26, 16
    s_add_u32 s83, s83, s96
    buffer_load_dwordx4 v12, s[56:59], s83 offen offset:0 lds
    s_waitcnt lgkmcnt(2)
    v_mfma_f32_16x16x32_bf16 v[144:147], v[232:235], a[16:19], v[144:147]
    ds_read_b128 a[44:47], v37 offset:10240
    s_waitcnt vmcnt(23)
    v_mfma_f32_16x16x32_bf16 v[152:155], v[236:239], a[16:19], v[152:155]
    buffer_load_dwordx4 v13, s[56:59], s83 offen offset:1024 lds
    v_mfma_f32_16x16x32_bf16 v[160:163], v[232:235], a[20:23], v[160:163]
    ds_read_b128 a[0:3], v37 offset:20480
    v_mfma_f32_16x16x32_bf16 v[168:171], v[236:239], a[20:23], v[168:171]
    v_mfma_f32_16x16x32_bf16 v[148:151], v[232:235], a[24:27], v[148:151]
    ds_read_b128 a[4:7], v37 offset:24576
    v_mfma_f32_16x16x32_bf16 v[156:159], v[236:239], a[24:27], v[156:159]
    buffer_load_dwordx4 v14, s[56:59], s83 offen offset:2048 lds
    v_mfma_f32_16x16x32_bf16 v[164:167], v[232:235], a[28:31], v[164:167]
    ds_read_b128 a[8:11], v37 offset:22528
    v_mfma_f32_16x16x32_bf16 v[172:175], v[236:239], a[28:31], v[172:175]
    s_waitcnt vmcnt(15)
    v_mfma_f32_16x16x32_bf16 v[144:147], v[240:243], a[32:35], v[144:147]
    ds_read_b128 a[12:15], v37 offset:26624
    s_waitcnt vmcnt(14)
    v_mfma_f32_16x16x32_bf16 v[152:155], v[244:247], a[32:35], v[152:155]
    buffer_load_dwordx4 v15, s[56:59], s83 offen offset:3072 lds
    s_waitcnt lgkmcnt(2)
    v_mfma_f32_16x16x32_bf16 v[160:163], v[240:243], a[36:39], v[160:163]
    v_add_u32 v4, 81920, v36
    ds_read_b128 a[16:19], v4 offset:4096
    v_mfma_f32_16x16x32_bf16 v[168:171], v[244:247], a[36:39], v[168:171]
    v_mfma_f32_16x16x32_bf16 v[148:151], v[240:243], a[40:43], v[148:151]
    ds_read_b128 a[20:23], v4 offset:8192
    v_mfma_f32_16x16x32_bf16 v[156:159], v[244:247], a[40:43], v[156:159]
    v_mfma_f32_16x16x32_bf16 v[164:167], v[240:243], a[44:47], v[164:167]
    ds_read_b128 a[24:27], v4 offset:6144
    v_mfma_f32_16x16x32_bf16 v[172:175], v[244:247], a[44:47], v[172:175]
    s_waitcnt vmcnt(14)
    v_mfma_f32_16x16x32_bf16 v[144:147], v[248:251], a[0:3], v[144:147]
    ds_read_b128 a[28:31], v4 offset:10240
    s_waitcnt vmcnt(13)
    v_mfma_f32_16x16x32_bf16 v[152:155], v[252:255], a[0:3], v[152:155]
    v_mfma_f32_16x16x32_bf16 v[160:163], v[248:251], a[4:7], v[160:163]
    v_add_u32 v5, 81920, v37
    ds_read_b128 a[32:35], v5 offset:4096
    v_mfma_f32_16x16x32_bf16 v[168:171], v[252:255], a[4:7], v[168:171]
    s_waitcnt lgkmcnt(3)
    v_mfma_f32_16x16x32_bf16 v[148:151], v[248:251], a[8:11], v[148:151]
    ds_read_b128 a[36:39], v5 offset:8192
    v_mfma_f32_16x16x32_bf16 v[156:159], v[252:255], a[8:11], v[156:159]
    v_mfma_f32_16x16x32_bf16 v[164:167], v[248:251], a[12:15], v[164:167]
    ds_read_b128 a[40:43], v5 offset:6144
    v_mfma_f32_16x16x32_bf16 v[172:175], v[252:255], a[12:15], v[172:175]
    s_waitcnt vmcnt(12)
    v_mfma_f32_16x16x32_bf16 v[144:147], v[96:99], a[16:19], v[144:147]
    ds_read_b128 a[44:47], v5 offset:10240
    s_waitcnt vmcnt(11)
    v_mfma_f32_16x16x32_bf16 v[152:155], v[100:103], a[16:19], v[152:155]
    v_mfma_f32_16x16x32_bf16 v[160:163], v[96:99], a[20:23], v[160:163]
    ds_read_b128 a[0:3], v4 offset:20480
    v_mfma_f32_16x16x32_bf16 v[168:171], v[100:103], a[20:23], v[168:171]
    s_waitcnt lgkmcnt(3)
    v_mfma_f32_16x16x32_bf16 v[148:151], v[96:99], a[24:27], v[148:151]
    ds_read_b128 a[4:7], v4 offset:24576
    v_mfma_f32_16x16x32_bf16 v[156:159], v[100:103], a[24:27], v[156:159]
    v_mfma_f32_16x16x32_bf16 v[164:167], v[96:99], a[28:31], v[164:167]
    ds_read_b128 a[8:11], v4 offset:22528
    v_mfma_f32_16x16x32_bf16 v[172:175], v[100:103], a[28:31], v[172:175]
    s_waitcnt vmcnt(10)
    v_mfma_f32_16x16x32_bf16 v[144:147], v[104:107], a[32:35], v[144:147]
    ds_read_b128 a[12:15], v4 offset:26624
    s_waitcnt vmcnt(9)
    v_mfma_f32_16x16x32_bf16 v[152:155], v[108:111], a[32:35], v[152:155]
    s_waitcnt vmcnt(4)
    v_cmp_ne_u32 vcc, s76, v31
    s_cbranch_vccnz L_retry_fl
L_back_fl:
    buffer_load_dwordx4 v[64:67], v28, s[60:63], s14 offen offset:0 sc1
    v_mfma_f32_16x16x32_bf16 v[160:163], v[104:107], a[36:39], v[160:163]
    ds_read_b128 a[16:19], v5 offset:20480
    v_mfma_f32_16x16x32_bf16 v[168:171], v[108:111], a[36:39], v[168:171]
    buffer_load_dwordx4 v[68:71], v28, s[60:63], s14 offen offset:1024 sc1
    s_waitcnt lgkmcnt(2)
    v_mfma_f32_16x16x32_bf16 v[148:151], v[104:107], a[40:43], v[148:151]
    ds_read_b128 a[20:23], v5 offset:24576
    v_mfma_f32_16x16x32_bf16 v[156:159], v[108:111], a[40:43], v[156:159]
    v_mfma_f32_16x16x32_bf16 v[164:167], v[104:107], a[44:47], v[164:167]
    ds_read_b128 a[24:27], v5 offset:22528
    v_mfma_f32_16x16x32_bf16 v[172:175], v[108:111], a[44:47], v[172:175]
    buffer_load_dwordx4 v[72:75], v28, s[60:63], s14 offen offset:2048 sc1
    v_mfma_f32_16x16x32_bf16 v[144:147], v[112:115], a[0:3], v[144:147]
    ds_read_b128 a[28:31], v5 offset:26624
    v_mfma_f32_16x16x32_bf16 v[152:155], v[116:119], a[0:3], v[152:155]
    s_waitcnt vmcnt(3)
    s_barrier
    buffer_load_dwordx4 v[76:79], v28, s[60:63], s14 offen offset:3072 sc1
    v_mfma_f32_16x16x32_bf16 v[160:163], v[112:115], a[4:7], v[160:163]
    ds_read_b64_tr_b16 a[32:33], v22 offset:49152
    ds_read_b64_tr_b16 a[34:35], v22 offset:50176
    v_mfma_f32_16x16x32_bf16 v[168:171], v[116:119], a[4:7], v[168:171]
    v_mfma_f32_16x16x32_bf16 v[148:151], v[112:115], a[8:11], v[148:151]
    ds_read_b64_tr_b16 a[36:37], v20 offset:53248
    ds_read_b64_tr_b16 a[38:39], v20 offset:54272
    v_mfma_f32_16x16x32_bf16 v[156:159], v[116:119], a[8:11], v[156:159]
    buffer_load_dwordx4 v[48:51], v28, s[60:63], s15 offen offset:0 sc1
    s_waitcnt lgkmcnt(4)
    v_mfma_f32_16x16x32_bf16 v[164:167], v[112:115], a[12:15], v[164:167]
    ds_read_b64_tr_b16 a[40:41], v23 offset:49152
    ds_read_b64_tr_b16 a[42:43], v23 offset:50176
    v_mfma_f32_16x16x32_bf16 v[172:175], v[116:119], a[12:15], v[172:175]
    buffer_load_dwordx4 v[52:55], v28, s[60:63], s15 offen offset:1024 sc1
    v_mfma_f32_16x16x32_bf16 v[144:147], v[120:123], a[16:19], v[144:147]
    ds_read_b64_tr_b16 a[44:45], v21 offset:53248
    ds_read_b64_tr_b16 a[46:47], v21 offset:54272
    v_mfma_f32_16x16x32_bf16 v[152:155], v[124:127], a[16:19], v[152:155]
    v_mfma_f32_16x16x32_bf16 v[160:163], v[120:123], a[20:23], v[160:163]
    ds_read_b64_tr_b16 a[0:1], v22 offset:57344
    ds_read_b64_tr_b16 a[2:3], v22 offset:58368
    v_mfma_f32_16x16x32_bf16 v[168:171], v[124:127], a[20:23], v[168:171]
    buffer_load_dwordx4 v[56:59], v28, s[60:63], s15 offen offset:2048 sc1
    v_mfma_f32_16x16x32_bf16 v[148:151], v[120:123], a[24:27], v[148:151]
    ds_read_b64_tr_b16 a[4:5], v20 offset:61440
    ds_read_b64_tr_b16 a[6:7], v20 offset:62464
    v_mfma_f32_16x16x32_bf16 v[156:159], v[124:127], a[24:27], v[156:159]
    v_mfma_f32_16x16x32_bf16 v[164:167], v[120:123], a[28:31], v[164:167]
    ds_read_b64_tr_b16 a[8:9], v23 offset:57344
    ds_read_b64_tr_b16 a[10:11], v23 offset:58368
    v_mfma_f32_16x16x32_bf16 v[172:175], v[124:127], a[28:31], v[172:175]
    buffer_load_dwordx4 v[60:63], v28, s[60:63], s15 offen offset:3072 sc1
    s_waitcnt lgkmcnt(4)
    v_mfma_f32_16x16x32_bf16 v[144:147], a[80:83], a[32:35], v[144:147]
    ds_read_b64_tr_b16 a[12:13], v21 offset:61440
    ds_read_b64_tr_b16 a[14:15], v21 offset:62464
    v_mfma_f32_16x16x32_bf16 v[152:155], a[84:87], a[32:35], v[152:155]
    v_lshlrev_b32 v8, 2, v0
    v_lshrrev_b32 v2, 5, v0
    v_mfma_f32_16x16x32_bf16 v[160:163], a[80:83], a[36:39], v[160:163]
    v_add_u32 v22, 81920, v34
    ds_read_b64_tr_b16 a[16:17], v22 offset:49152
    ds_read_b64_tr_b16 a[18:19], v22 offset:50176
    v_mfma_f32_16x16x32_bf16 v[168:171], a[84:87], a[36:39], v[168:171]
    s_lshl_b32 s101, s74, 8
    v_mfma_f32_16x16x32_bf16 v[148:151], a[80:83], a[40:43], v[148:151]
    v_add_u32 v23, 81920, v35
    ds_read_b64_tr_b16 a[20:21], v23 offset:49152
    ds_read_b64_tr_b16 a[22:23], v23 offset:50176
    v_mfma_f32_16x16x32_bf16 v[156:159], a[84:87], a[40:43], v[156:159]
    s_add_u32 s101, s101, 147456
    v_mfma_f32_16x16x32_bf16 v[164:167], a[80:83], a[44:47], v[164:167]
    ds_read_b64_tr_b16 a[24:25], v22 offset:57344
    ds_read_b64_tr_b16 a[26:27], v22 offset:58368
    v_mfma_f32_16x16x32_bf16 v[172:175], a[84:87], a[44:47], v[172:175]
    v_lshl_add_u32 v27, v2, 4, s101
    v_mfma_f32_16x16x32_bf16 v[144:147], v[80:83], a[0:3], v[144:147]
    ds_read_b64_tr_b16 a[28:29], v23 offset:57344
    ds_read_b64_tr_b16 a[30:31], v23 offset:58368
    v_mfma_f32_16x16x32_bf16 v[152:155], v[84:87], a[0:3], v[152:155]
    v_lshlrev_b32 v24, 13, v2
    v_and_b32 v1, 31, v0
    s_waitcnt lgkmcnt(4)
    v_mfma_f32_16x16x32_bf16 v[160:163], v[80:83], a[4:7], v[160:163]
    ds_read_b64_tr_b16 a[32:33], v34 offset:32768
    ds_read_b64_tr_b16 a[34:35], v34 offset:33792
    v_mfma_f32_16x16x32_bf16 v[168:171], v[84:87], a[4:7], v[168:171]
    v_lshl_add_u32 v24, v1, 2, v24
    s_lshl_b32 s85, s85, 1
    v_mfma_f32_16x16x32_bf16 v[148:151], v[80:83], a[8:11], v[148:151]
    ds_read_b64_tr_b16 a[36:37], v35 offset:32768
    ds_read_b64_tr_b16 a[38:39], v35 offset:33792
    v_mfma_f32_16x16x32_bf16 v[156:159], v[84:87], a[8:11], v[156:159]
    s_mov_b32 s78, 0x00003f80
    s_mov_b32 s79, 0x3f800000
    v_mfma_f32_16x16x32_bf16 v[164:167], v[80:83], a[12:15], v[164:167]
    ds_read_b64_tr_b16 a[40:41], v34 offset:40960
    ds_read_b64_tr_b16 a[42:43], v34 offset:41984
    v_mfma_f32_16x16x32_bf16 v[172:175], v[84:87], a[12:15], v[172:175]
    s_waitcnt vmcnt(7)
    v_mfma_f32_16x16x32_bf16 v[144:147], v[64:67], a[16:19], v[144:147]
    ds_read_b64_tr_b16 a[44:45], v35 offset:40960
    ds_read_b64_tr_b16 a[46:47], v35 offset:41984
    s_waitcnt vmcnt(6)
    v_mfma_f32_16x16x32_bf16 v[152:155], v[68:71], a[16:19], v[152:155]
    v_mfma_f32_16x16x32_bf16 v[148:151], v[64:67], a[20:23], v[148:151]
    v_add_u32 v20, 81920, v32
    ds_read_b64_tr_b16 a[0:1], v20 offset:53248
    ds_read_b64_tr_b16 a[2:3], v20 offset:54272
    v_mfma_f32_16x16x32_bf16 v[156:159], v[68:71], a[20:23], v[156:159]
    s_waitcnt vmcnt(5) lgkmcnt(4)
    v_mfma_f32_16x16x32_bf16 v[144:147], v[72:75], a[24:27], v[144:147]
    v_add_u32 v21, 81920, v33
    ds_read_b64_tr_b16 a[4:5], v21 offset:53248
    ds_read_b64_tr_b16 a[6:7], v21 offset:54272
    s_waitcnt vmcnt(4)
    v_mfma_f32_16x16x32_bf16 v[152:155], v[76:79], a[24:27], v[152:155]
    v_mfma_f32_16x16x32_bf16 v[148:151], v[72:75], a[28:31], v[148:151]
    ds_read_b64_tr_b16 a[8:9], v20 offset:61440
    ds_read_b64_tr_b16 a[10:11], v20 offset:62464
    v_mfma_f32_16x16x32_bf16 v[156:159], v[76:79], a[28:31], v[156:159]
    s_waitcnt vmcnt(3)
    v_mfma_f32_16x16x32_bf16 v[144:147], v[48:51], a[32:35], v[144:147]
    ds_read_b64_tr_b16 a[12:13], v21 offset:61440
    ds_read_b64_tr_b16 a[14:15], v21 offset:62464
    s_waitcnt vmcnt(2)
    v_mfma_f32_16x16x32_bf16 v[152:155], v[52:55], a[32:35], v[152:155]
    v_mfma_f32_16x16x32_bf16 v[148:151], v[48:51], a[36:39], v[148:151]
    ds_read_b64_tr_b16 a[16:17], v32 offset:36864
    ds_read_b64_tr_b16 a[18:19], v32 offset:37888
    v_mfma_f32_16x16x32_bf16 v[156:159], v[52:55], a[36:39], v[156:159]
    s_waitcnt vmcnt(1)
    v_mfma_f32_16x16x32_bf16 v[144:147], v[56:59], a[40:43], v[144:147]
    ds_read_b64_tr_b16 a[20:21], v33 offset:36864
    ds_read_b64_tr_b16 a[22:23], v33 offset:37888
    s_waitcnt vmcnt(0)
    v_mfma_f32_16x16x32_bf16 v[152:155], v[60:63], a[40:43], v[152:155]
    s_waitcnt lgkmcnt(4)
    v_mfma_f32_16x16x32_bf16 v[148:151], v[56:59], a[44:47], v[148:151]
    ds_read_b64_tr_b16 a[24:25], v32 offset:45056
    ds_read_b64_tr_b16 a[26:27], v32 offset:46080
    v_mfma_f32_16x16x32_bf16 v[156:159], v[60:63], a[44:47], v[156:159]
    v_mfma_f32_16x16x32_bf16 v[160:163], v[64:67], a[0:3], v[160:163]
    ds_read_b64_tr_b16 a[28:29], v33 offset:45056
    ds_read_b64_tr_b16 a[30:31], v33 offset:46080
    v_mfma_f32_16x16x32_bf16 v[168:171], v[68:71], a[0:3], v[168:171]
    v_mfma_f32_16x16x32_bf16 v[164:167], v[64:67], a[4:7], v[164:167]
    v_mfma_f32_16x16x32_bf16 v[172:175], v[68:71], a[4:7], v[172:175]
    v_mfma_f32_16x16x32_bf16 v[160:163], v[72:75], a[8:11], v[160:163]
    v_mfma_f32_16x16x32_bf16 v[168:171], v[76:79], a[8:11], v[168:171]
    v_cvt_pk_bf16_f32 v144, v144, v145
    v_cvt_pk_bf16_f32 v145, v146, v147
    v_cvt_pk_bf16_f32 v146, v148, v149
    v_mfma_f32_16x16x32_bf16 v[164:167], v[72:75], a[12:15], v[164:167]
    v_mfma_f32_16x16x32_bf16 v[172:175], v[76:79], a[12:15], v[172:175]
    v_cvt_pk_bf16_f32 v147, v150, v151
    buffer_store_dwordx4 v[144:147], v28, s[60:63], s28 offen offset:0 sc1
    v_cvt_pk_bf16_f32 v148, v152, v153
    v_cvt_pk_bf16_f32 v149, v154, v155
    s_waitcnt lgkmcnt(0)
    v_mfma_f32_16x16x32_bf16 v[160:163], v[48:51], a[16:19], v[160:163]
    v_mfma_f32_16x16x32_bf16 v[168:171], v[52:55], a[16:19], v[168:171]
    v_cvt_pk_bf16_f32 v150, v156, v157
    v_cvt_pk_bf16_f32 v151, v158, v159
    buffer_store_dwordx4 v[148:151], v28, s[60:63], s28 offen offset:1024 sc1
    v_bitop3_b32 v152, v144, v145, s76 bitop3:0x96
    v_mfma_f32_16x16x32_bf16 v[164:167], v[48:51], a[20:23], v[164:167]
    ds_read_b64_tr_b16 a[32:33], v34 offset:53248
    ds_read_b64_tr_b16 a[34:35], v34 offset:54272
    v_mfma_f32_16x16x32_bf16 v[172:175], v[52:55], a[20:23], v[172:175]
    v_bitop3_b32 v152, v146, v147, v152 bitop3:0x96
    v_bitop3_b32 v152, v148, v149, v152 bitop3:0x96
    v_bitop3_b32 v152, v150, v151, v152 bitop3:0x96
    buffer_store_dword v152, v8, s[60:63], s28 offen offset:2048 sc1
    v_mfma_f32_16x16x32_bf16 v[160:163], v[56:59], a[24:27], v[160:163]
    ds_read_b64_tr_b16 a[36:37], v35 offset:53248
    ds_read_b64_tr_b16 a[38:39], v35 offset:54272
    v_mfma_f32_16x16x32_bf16 v[168:171], v[60:63], a[24:27], v[168:171]
    v_mfma_f32_16x16x32_bf16 v[164:167], v[56:59], a[28:31], v[164:167]
    ds_read_b64_tr_b16 a[40:41], v34 offset:61440
    ds_read_b64_tr_b16 a[42:43], v34 offset:62464
    v_mfma_f32_16x16x32_bf16 v[172:175], v[60:63], a[28:31], v[172:175]
    v_mfma_f32_16x16x32_bf16 v[128:131], v[192:195], a[128:131], v[128:131]
    ds_read_b64_tr_b16 a[44:45], v35 offset:61440
    ds_read_b64_tr_b16 a[46:47], v35 offset:62464
    v_mfma_f32_16x16x32_bf16 v[136:139], v[196:199], a[128:131], v[136:139]
    v_mfma_f32_16x16x32_bf16 v[132:135], v[192:195], a[132:135], v[132:135]
    v_add_u32 v22, 65536, v34
    ds_read_b64_tr_b16 a[0:1], v22 offset:4096
    ds_read_b64_tr_b16 a[2:3], v22 offset:5120
    v_mfma_f32_16x16x32_bf16 v[140:143], v[196:199], a[132:135], v[140:143]
    v_mfma_f32_16x16x32_bf16 v[128:131], v[200:203], a[136:139], v[128:131]
    v_add_u32 v23, 65536, v35
    ds_read_b64_tr_b16 a[4:5], v23 offset:4096
    ds_read_b64_tr_b16 a[6:7], v23 offset:5120
    v_mfma_f32_16x16x32_bf16 v[136:139], v[204:207], a[136:139], v[136:139]
    v_cvt_pk_bf16_f32 v160, v160, v161
    v_cvt_pk_bf16_f32 v161, v162, v163
    v_cvt_pk_bf16_f32 v162, v164, v165
    v_mfma_f32_16x16x32_bf16 v[132:135], v[200:203], a[140:143], v[132:135]
    ds_read_b64_tr_b16 a[8:9], v22 offset:12288
    ds_read_b64_tr_b16 a[10:11], v22 offset:13312
    v_mfma_f32_16x16x32_bf16 v[140:143], v[204:207], a[140:143], v[140:143]
    v_cvt_pk_bf16_f32 v163, v166, v167
    buffer_store_dwordx4 v[160:163], v28, s[60:63], s29 offen offset:0 sc1
    ds_read_b128 v[40:43], v27 offset:0
    v_cvt_pk_bf16_f32 v164, v168, v169
    v_cvt_pk_bf16_f32 v165, v170, v171
    ds_read_b128 v[44:47], v27 offset:128
    s_waitcnt lgkmcnt(4)
    v_mfma_f32_16x16x32_bf16 v[176:179], v[208:211], a[32:35], v[176:179]
    ds_read_b64_tr_b16 a[12:13], v23 offset:12288
    ds_read_b64_tr_b16 a[14:15], v23 offset:13312
    v_mfma_f32_16x16x32_bf16 v[184:187], v[212:215], a[32:35], v[184:187]
    v_cvt_pk_bf16_f32 v166, v172, v173
    v_cvt_pk_bf16_f32 v167, v174, v175
    buffer_store_dwordx4 v[164:167], v28, s[60:63], s29 offen offset:1024 sc1
    v_bitop3_b32 v168, v160, v161, s76 bitop3:0x96
    v_mfma_f32_16x16x32_bf16 v[180:183], v[208:211], a[36:39], v[180:183]
    ds_read_b128 a[16:19], v37 offset:12288
    v_mfma_f32_16x16x32_bf16 v[188:191], v[212:215], a[36:39], v[188:191]
    v_bitop3_b32 v168, v162, v163, v168 bitop3:0x96
    v_bitop3_b32 v168, v164, v165, v168 bitop3:0x96
    v_bitop3_b32 v168, v166, v167, v168 bitop3:0x96
    buffer_store_dword v168, v8, s[60:63], s29 offen offset:2048 sc1
    v_mfma_f32_16x16x32_bf16 v[176:179], v[216:219], a[40:43], v[176:179]
    ds_read_b128 a[20:23], v37 offset:14336
    v_mfma_f32_16x16x32_bf16 v[184:187], v[220:223], a[40:43], v[184:187]
    v_mfma_f32_16x16x32_bf16 v[180:183], v[216:219], a[44:47], v[180:183]
    ds_read_b128 a[24:27], v37 offset:28672
    v_accvgpr_read_b32 v26, a240
    v_mfma_f32_16x16x32_bf16 v[188:191], v[220:223], a[44:47], v[188:191]
    v_mfma_f32_16x16x32_bf16 v[176:179], v[224:227], a[0:3], v[176:179]
    ds_read_b128 a[28:31], v37 offset:30720
    v_mfma_f32_16x16x32_bf16 v[184:187], v[228:231], a[0:3], v[184:187]
    v_accvgpr_read_b32 v192, a224
    v_accvgpr_read_b32 v193, a225
    v_mfma_f32_16x16x32_bf16 v[180:183], v[224:227], a[4:7], v[180:183]
    ds_read_b128 a[32:35], v4 offset:12288
    v_mfma_f32_16x16x32_bf16 v[188:191], v[228:231], a[4:7], v[188:191]
    v_accvgpr_read_b32 v194, a226
    v_accvgpr_read_b32 v195, a227
    s_waitcnt lgkmcnt(2)
    v_mfma_f32_16x16x32_bf16 v[176:179], v[232:235], a[8:11], v[176:179]
    ds_read_b128 a[36:39], v4 offset:14336
    v_sub_f32 v40, v192, v40
    v_mfma_f32_16x16x32_bf16 v[184:187], v[236:239], a[8:11], v[184:187]
    v_sub_f32 v41, v193, v41
    v_mfma_f32_16x16x32_bf16 v[180:183], v[232:235], a[12:15], v[180:183]
    ds_read_b128 a[40:43], v5 offset:12288
    v_sub_f32 v42, v194, v42
    v_mfma_f32_16x16x32_bf16 v[188:191], v[236:239], a[12:15], v[188:191]
    v_sub_f32 v43, v195, v43
    v_mul_f32 v40, v40, v44
    v_mfma_f32_16x16x32_bf16 v[176:179], v[240:243], a[16:19], v[176:179]
    ds_read_b128 a[44:47], v5 offset:14336
    v_mfma_f32_16x16x32_bf16 v[184:187], v[244:247], a[16:19], v[184:187]
    v_mul_f32 v41, v41, v45
    v_mul_f32 v42, v42, v46
    v_mfma_f32_16x16x32_bf16 v[180:183], v[240:243], a[20:23], v[180:183]
    ds_read_b128 a[0:3], v4 offset:28672
    v_mul_f32 v43, v43, v47
    ds_read_b128 v[44:47], v27 offset:192
    v_mfma_f32_16x16x32_bf16 v[188:191], v[244:247], a[20:23], v[188:191]
    v_fmac_f32 v192, v40, v26
    v_mfma_f32_16x16x32_bf16 v[176:179], v[248:251], a[24:27], v[176:179]
    ds_read_b128 a[4:7], v4 offset:30720
    v_fmac_f32 v193, v41, v26
    v_mfma_f32_16x16x32_bf16 v[184:187], v[252:255], a[24:27], v[184:187]
    v_fmac_f32 v194, v42, v26
    v_fmac_f32 v195, v43, v26
    ds_read_b128 v[40:43], v27 offset:64
    s_waitcnt lgkmcnt(4)
    v_mfma_f32_16x16x32_bf16 v[180:183], v[248:251], a[28:31], v[180:183]
    ds_read_b128 a[8:11], v5 offset:28672
    v_mfma_f32_16x16x32_bf16 v[188:191], v[252:255], a[28:31], v[188:191]
    v_mfma_f32_16x16x32_bf16 v[176:179], v[96:99], a[32:35], v[176:179]
    ds_read_b128 a[12:15], v5 offset:30720
    v_accvgpr_read_b32 v196, a228
    v_mfma_f32_16x16x32_bf16 v[184:187], v[100:103], a[32:35], v[184:187]
    v_accvgpr_read_b32 v197, a229
    v_mfma_f32_16x16x32_bf16 v[180:183], v[96:99], a[36:39], v[180:183]
    ds_read_b64_tr_b16 a[16:17], v22 offset:53248
    ds_read_b64_tr_b16 a[18:19], v22 offset:54272
    v_mfma_f32_16x16x32_bf16 v[188:191], v[100:103], a[36:39], v[188:191]
    v_accvgpr_read_b32 v198, a230
    v_accvgpr_read_b32 v199, a231
    v_mfma_f32_16x16x32_bf16 v[176:179], v[104:107], a[40:43], v[176:179]
    ds_read_b64_tr_b16 a[20:21], v23 offset:53248
    ds_read_b64_tr_b16 a[22:23], v23 offset:54272
    v_mfma_f32_16x16x32_bf16 v[184:187], v[108:111], a[40:43], v[184:187]
    s_waitcnt lgkmcnt(4)
    v_sub_f32 v40, v196, v40
    v_mfma_f32_16x16x32_bf16 v[180:183], v[104:107], a[44:47], v[180:183]
    ds_read_b64_tr_b16 a[24:25], v22 offset:61440
    ds_read_b64_tr_b16 a[26:27], v22 offset:62464
    v_mfma_f32_16x16x32_bf16 v[188:191], v[108:111], a[44:47], v[188:191]
    v_sub_f32 v41, v197, v41
    v_sub_f32 v42, v198, v42
    v_mfma_f32_16x16x32_bf16 v[176:179], v[112:115], a[0:3], v[176:179]
    ds_read_b64_tr_b16 a[28:29], v23 offset:61440
    ds_read_b64_tr_b16 a[30:31], v23 offset:62464
    v_mfma_f32_16x16x32_bf16 v[184:187], v[116:119], a[0:3], v[184:187]
    v_sub_f32 v43, v199, v43
    v_mfma_f32_16x16x32_bf16 v[180:183], v[112:115], a[4:7], v[180:183]
    v_add_u32 v22, 81920, v34
    ds_read_b64_tr_b16 a[32:33], v22 offset:53248
    ds_read_b64_tr_b16 a[34:35], v22 offset:54272
    v_mfma_f32_16x16x32_bf16 v[188:191], v[116:119], a[4:7], v[188:191]
    v_mfma_f32_16x16x32_bf16 v[176:179], v[120:123], a[8:11], v[176:179]
    v_add_u32 v23, 81920, v35
    ds_read_b64_tr_b16 a[36:37], v23 offset:53248
    ds_read_b64_tr_b16 a[38:39], v23 offset:54272
    v_mfma_f32_16x16x32_bf16 v[184:187], v[124:127], a[8:11], v[184:187]
    v_mul_f32 v40, v40, v44
    v_mfma_f32_16x16x32_bf16 v[180:183], v[120:123], a[12:15], v[180:183]
    ds_read_b64_tr_b16 a[40:41], v22 offset:61440
    ds_read_b64_tr_b16 a[42:43], v22 offset:62464
    v_mfma_f32_16x16x32_bf16 v[188:191], v[124:127], a[12:15], v[188:191]
    v_mul_f32 v41, v41, v45
    s_waitcnt lgkmcnt(4)
    v_mfma_f32_16x16x32_bf16 v[176:179], a[80:83], a[16:19], v[176:179]
    ds_read_b64_tr_b16 a[44:45], v23 offset:61440
    ds_read_b64_tr_b16 a[46:47], v23 offset:62464
    v_mfma_f32_16x16x32_bf16 v[184:187], a[84:87], a[16:19], v[184:187]
    v_mul_f32 v42, v42, v46
    v_mfma_f32_16x16x32_bf16 v[180:183], a[80:83], a[20:23], v[180:183]
    ds_read_b64_tr_b16 a[0:1], v34 offset:36864
    ds_read_b64_tr_b16 a[2:3], v34 offset:37888
    v_mfma_f32_16x16x32_bf16 v[188:191], a[84:87], a[20:23], v[188:191]
    v_mul_f32 v43, v43, v47
    v_fmac_f32 v196, v40, v26
    v_mfma_f32_16x16x32_bf16 v[176:179], v[80:83], a[24:27], v[176:179]
    ds_read_b64_tr_b16 a[4:5], v35 offset:36864
    ds_read_b128 v[44:47], v27 offset:160
    ds_read_b64_tr_b16 a[6:7], v35 offset:37888
    v_mfma_f32_16x16x32_bf16 v[184:187], v[84:87], a[24:27], v[184:187]
    v_fmac_f32 v197, v41, v26
    v_mfma_f32_16x16x32_bf16 v[180:183], v[80:83], a[28:31], v[180:183]
    ds_read_b64_tr_b16 a[8:9], v34 offset:45056
    ds_read_b64_tr_b16 a[10:11], v34 offset:46080
    v_mfma_f32_16x16x32_bf16 v[188:191], v[84:87], a[28:31], v[188:191]
    v_fmac_f32 v198, v42, v26
    v_mfma_f32_16x16x32_bf16 v[176:179], v[64:67], a[32:35], v[176:179]
    ds_read_b64_tr_b16 a[12:13], v35 offset:45056
    ds_read_b64_tr_b16 a[14:15], v35 offset:46080
    v_mfma_f32_16x16x32_bf16 v[184:187], v[68:71], a[32:35], v[184:187]
    v_fmac_f32 v199, v43, v26
    ds_read_b128 v[40:43], v27 offset:32
    s_waitcnt lgkmcnt(5)
    v_mfma_f32_16x16x32_bf16 v[180:183], v[64:67], a[36:39], v[180:183]
    ds_read_b128 a[16:19], v36 offset:0
    v_mfma_f32_16x16x32_bf16 v[188:191], v[68:71], a[36:39], v[188:191]
    buffer_load_dwordx4 v[144:147], v28, s[60:63], s27 offen offset:0 sc1
    buffer_load_dwordx4 v[148:151], v28, s[60:63], s27 offen offset:1024 sc1
    buffer_load_dword v152, v8, s[60:63], s27 offen offset:2048 sc1
    v_mfma_f32_16x16x32_bf16 v[176:179], v[72:75], a[40:43], v[176:179]
    ds_read_b128 a[20:23], v36 offset:2048
    v_mfma_f32_16x16x32_bf16 v[184:187], v[76:79], a[40:43], v[184:187]
    v_mfma_f32_16x16x32_bf16 v[180:183], v[72:75], a[44:47], v[180:183]
    ds_read_b128 a[24:27], v36 offset:16384
    v_accvgpr_read_b32 v200, a232
    v_mfma_f32_16x16x32_bf16 v[188:191], v[76:79], a[44:47], v[188:191]
    v_accvgpr_read_b32 v201, a233
    v_accvgpr_read_b32 v202, a234
    v_mfma_f32_16x16x32_bf16 v[176:179], v[48:51], a[0:3], v[176:179]
    ds_read_b128 a[28:31], v36 offset:18432
    v_mfma_f32_16x16x32_bf16 v[184:187], v[52:55], a[0:3], v[184:187]
    v_accvgpr_read_b32 v203, a235
    s_waitcnt lgkmcnt(2)
    v_sub_f32 v40, v200, v40
    v_mfma_f32_16x16x32_bf16 v[180:183], v[48:51], a[4:7], v[180:183]
    ds_read_b64_tr_b16 a[32:33], v32 offset:49152
    ds_read_b64_tr_b16 a[34:35], v32 offset:50176
    v_mfma_f32_16x16x32_bf16 v[188:191], v[52:55], a[4:7], v[188:191]
    v_sub_f32 v41, v201, v41
    v_mfma_f32_16x16x32_bf16 v[176:179], v[56:59], a[8:11], v[176:179]
    ds_read_b64_tr_b16 a[36:37], v33 offset:49152
    ds_read_b64_tr_b16 a[38:39], v33 offset:50176
    v_mfma_f32_16x16x32_bf16 v[184:187], v[60:63], a[8:11], v[184:187]
    v_sub_f32 v42, v202, v42
    v_sub_f32 v43, v203, v43
    v_mfma_f32_16x16x32_bf16 v[180:183], v[56:59], a[12:15], v[180:183]
    ds_read_b64_tr_b16 a[40:41], v32 offset:57344
    ds_read_b64_tr_b16 a[42:43], v32 offset:58368
    v_mfma_f32_16x16x32_bf16 v[188:191], v[60:63], a[12:15], v[188:191]
    buffer_load_dwordx4 v[160:163], v28, s[60:63], s33 offen offset:0 sc1
    buffer_load_dwordx4 v[164:167], v28, s[60:63], s33 offen offset:1024 sc1
    buffer_load_dword v168, v8, s[60:63], s33 offen offset:2048 sc1
    v_mfma_f32_16x16x32_bf16 v[128:131], a[88:91], a[16:19], v[128:131]
    ds_read_b64_tr_b16 a[44:45], v33 offset:57344
    ds_read_b64_tr_b16 a[46:47], v33 offset:58368
    v_mfma_f32_16x16x32_bf16 v[136:139], a[92:95], a[16:19], v[136:139]
    v_mfma_f32_16x16x32_bf16 v[132:135], a[88:91], a[20:23], v[132:135]
    v_add_u32 v20, 65536, v32
    ds_read_b64_tr_b16 a[0:1], v20 offset:0
    ds_read_b64_tr_b16 a[2:3], v20 offset:1024
    v_mfma_f32_16x16x32_bf16 v[140:143], a[92:95], a[20:23], v[140:143]
    s_waitcnt lgkmcnt(4)
    v_mfma_f32_16x16x32_bf16 v[128:131], a[96:99], a[24:27], v[128:131]
    v_add_u32 v21, 65536, v33
    ds_read_b64_tr_b16 a[4:5], v21 offset:0
    ds_read_b64_tr_b16 a[6:7], v21 offset:1024
    v_mfma_f32_16x16x32_bf16 v[136:139], a[100:103], a[24:27], v[136:139]
    v_cvt_pk_bf16_f32 v176, v176, v177
    v_cvt_pk_bf16_f32 v177, v178, v179
    v_cvt_pk_bf16_f32 v178, v180, v181
    v_mfma_f32_16x16x32_bf16 v[132:135], a[96:99], a[28:31], v[132:135]
    ds_read_b64_tr_b16 a[8:9], v20 offset:8192
    ds_read_b64_tr_b16 a[10:11], v20 offset:9216
    v_mfma_f32_16x16x32_bf16 v[140:143], a[100:103], a[28:31], v[140:143]
    v_cvt_pk_bf16_f32 v179, v182, v183
    buffer_store_dwordx4 v[176:179], v28, s[60:63], s30 offen offset:0 sc1
    v_cvt_pk_bf16_f32 v180, v184, v185
    v_cvt_pk_bf16_f32 v181, v186, v187
    v_mfma_f32_16x16x32_bf16 v[128:131], v[208:211], a[32:35], v[128:131]
    ds_read_b64_tr_b16 a[12:13], v21 offset:8192
    ds_read_b64_tr_b16 a[14:15], v21 offset:9216
    v_mfma_f32_16x16x32_bf16 v[136:139], v[212:215], a[32:35], v[136:139]
    v_cvt_pk_bf16_f32 v182, v188, v189
    v_cvt_pk_bf16_f32 v183, v190, v191
    buffer_store_dwordx4 v[180:183], v28, s[60:63], s30 offen offset:1024 sc1
    v_bitop3_b32 v184, v176, v177, s76 bitop3:0x96
    v_mfma_f32_16x16x32_bf16 v[132:135], v[208:211], a[36:39], v[132:135]
    ds_read_b128 a[16:19], v37 offset:0
    v_mfma_f32_16x16x32_bf16 v[140:143], v[212:215], a[36:39], v[140:143]
    v_bitop3_b32 v184, v178, v179, v184 bitop3:0x96
    v_bitop3_b32 v184, v180, v181, v184 bitop3:0x96
    v_bitop3_b32 v184, v182, v183, v184 bitop3:0x96
    buffer_store_dword v184, v8, s[60:63], s30 offen offset:2048 sc1
    v_mfma_f32_16x16x32_bf16 v[128:131], v[216:219], a[40:43], v[128:131]
    ds_read_b128 a[20:23], v37 offset:2048
    v_mfma_f32_16x16x32_bf16 v[136:139], v[220:223], a[40:43], v[136:139]
    s_waitcnt lgkmcnt(2)
    v_mfma_f32_16x16x32_bf16 v[132:135], v[216:219], a[44:47], v[132:135]
    ds_read_b128 a[24:27], v37 offset:16384
    v_mfma_f32_16x16x32_bf16 v[140:143], v[220:223], a[44:47], v[140:143]
    v_mfma_f32_16x16x32_bf16 v[128:131], v[224:227], a[0:3], v[128:131]
    ds_read_b128 a[28:31], v37 offset:18432
    v_mfma_f32_16x16x32_bf16 v[136:139], v[228:231], a[0:3], v[136:139]
    v_mfma_f32_16x16x32_bf16 v[132:135], v[224:227], a[4:7], v[132:135]
    ds_read_b128 a[32:35], v4 offset:0
    v_mfma_f32_16x16x32_bf16 v[140:143], v[228:231], a[4:7], v[140:143]
    v_mfma_f32_16x16x32_bf16 v[128:131], v[232:235], a[8:11], v[128:131]
    ds_read_b128 a[36:39], v4 offset:2048
    v_mfma_f32_16x16x32_bf16 v[136:139], v[236:239], a[8:11], v[136:139]
    v_mul_f32 v40, v40, v44
    v_mul_f32 v41, v41, v45
    v_mfma_f32_16x16x32_bf16 v[132:135], v[232:235], a[12:15], v[132:135]
    ds_read_b128 a[40:43], v5 offset:0
    v_mul_f32 v42, v42, v46
    v_mfma_f32_16x16x32_bf16 v[140:143], v[236:239], a[12:15], v[140:143]
    v_mul_f32 v43, v43, v47
    ds_read_b128 v[44:47], v27 offset:224
    s_waitcnt lgkmcnt(3)
    v_mfma_f32_16x16x32_bf16 v[128:131], v[240:243], a[16:19], v[128:131]
    ds_read_b128 a[44:47], v5 offset:2048
    v_fmac_f32 v200, v40, v26
    v_mfma_f32_16x16x32_bf16 v[136:139], v[244:247], a[16:19], v[136:139]
    v_fmac_f32 v201, v41, v26
    v_fmac_f32 v202, v42, v26
    v_mfma_f32_16x16x32_bf16 v[132:135], v[240:243], a[20:23], v[132:135]
    ds_read_b128 a[0:3], v4 offset:16384
    v_mfma_f32_16x16x32_bf16 v[140:143], v[244:247], a[20:23], v[140:143]
    v_fmac_f32 v203, v43, v26
    ds_read_b128 v[40:43], v27 offset:96
    v_mfma_f32_16x16x32_bf16 v[128:131], v[248:251], a[24:27], v[128:131]
    ds_read_b128 a[4:7], v4 offset:18432
    v_mfma_f32_16x16x32_bf16 v[136:139], v[252:255], a[24:27], v[136:139]
    v_accvgpr_read_b32 v204, a236
    v_mfma_f32_16x16x32_bf16 v[132:135], v[248:251], a[28:31], v[132:135]
    ds_read_b128 a[8:11], v5 offset:16384
    v_accvgpr_read_b32 v205, a237
    v_mfma_f32_16x16x32_bf16 v[140:143], v[252:255], a[28:31], v[140:143]
    v_accvgpr_read_b32 v206, a238
    v_accvgpr_read_b32 v207, a239
    v_mfma_f32_16x16x32_bf16 v[128:131], v[96:99], a[32:35], v[128:131]
    ds_read_b128 a[12:15], v5 offset:18432
    v_mfma_f32_16x16x32_bf16 v[136:139], v[100:103], a[32:35], v[136:139]
    s_waitcnt lgkmcnt(2)
    v_sub_f32 v40, v204, v40
    v_sub_f32 v41, v205, v41
    v_mfma_f32_16x16x32_bf16 v[132:135], v[96:99], a[36:39], v[132:135]
    ds_read_b64_tr_b16 a[16:17], v20 offset:49152
    ds_read_b64_tr_b16 a[18:19], v20 offset:50176
    v_mfma_f32_16x16x32_bf16 v[140:143], v[100:103], a[36:39], v[140:143]
    v_sub_f32 v42, v206, v42
    v_mfma_f32_16x16x32_bf16 v[128:131], v[104:107], a[40:43], v[128:131]
    ds_read_b64_tr_b16 a[20:21], v21 offset:49152
    ds_read_b64_tr_b16 a[22:23], v21 offset:50176
    v_mfma_f32_16x16x32_bf16 v[136:139], v[108:111], a[40:43], v[136:139]
    v_sub_f32 v43, v207, v43
    v_mul_f32 v40, v40, v44
    v_mfma_f32_16x16x32_bf16 v[132:135], v[104:107], a[44:47], v[132:135]
    ds_read_b64_tr_b16 a[24:25], v20 offset:57344
    ds_read_b64_tr_b16 a[26:27], v20 offset:58368
    v_mfma_f32_16x16x32_bf16 v[140:143], v[108:111], a[44:47], v[140:143]
    v_mul_f32 v41, v41, v45
    v_mfma_f32_16x16x32_bf16 v[128:131], v[112:115], a[0:3], v[128:131]
    ds_read_b64_tr_b16 a[28:29], v21 offset:57344
    ds_read_b64_tr_b16 a[30:31], v21 offset:58368
    v_mfma_f32_16x16x32_bf16 v[136:139], v[116:119], a[0:3], v[136:139]
    v_mul_f32 v42, v42, v46
    v_mfma_f32_16x16x32_bf16 v[132:135], v[112:115], a[4:7], v[132:135]
    v_add_u32 v20, 81920, v32
    ds_read_b64_tr_b16 a[32:33], v20 offset:49152
    ds_read_b64_tr_b16 a[34:35], v20 offset:50176
    v_mfma_f32_16x16x32_bf16 v[140:143], v[116:119], a[4:7], v[140:143]
    v_mul_f32 v43, v43, v47
    s_waitcnt lgkmcnt(4)
    v_mfma_f32_16x16x32_bf16 v[128:131], v[120:123], a[8:11], v[128:131]
    v_add_u32 v21, 81920, v33
    ds_read_b64_tr_b16 a[36:37], v21 offset:49152
    ds_read_b64_tr_b16 a[38:39], v21 offset:50176
    v_mfma_f32_16x16x32_bf16 v[136:139], v[124:127], a[8:11], v[136:139]
    v_mfma_f32_16x16x32_bf16 v[132:135], v[120:123], a[12:15], v[132:135]
    ds_read_b64_tr_b16 a[40:41], v20 offset:57344
    ds_read_b64_tr_b16 a[42:43], v20 offset:58368
    v_mfma_f32_16x16x32_bf16 v[140:143], v[124:127], a[12:15], v[140:143]
    v_fmac_f32 v204, v40, v26
    v_fmac_f32 v205, v41, v26
    v_mfma_f32_16x16x32_bf16 v[128:131], a[80:83], a[16:19], v[128:131]
    ds_read_b64_tr_b16 a[44:45], v21 offset:57344
    ds_read_b64_tr_b16 a[46:47], v21 offset:58368
    v_mfma_f32_16x16x32_bf16 v[136:139], a[84:87], a[16:19], v[136:139]
    v_fmac_f32 v206, v42, v26
    v_mfma_f32_16x16x32_bf16 v[132:135], a[80:83], a[20:23], v[132:135]
    ds_read_b64_tr_b16 a[0:1], v32 offset:32768
    ds_read_b64_tr_b16 a[2:3], v32 offset:33792
    v_mfma_f32_16x16x32_bf16 v[140:143], a[84:87], a[20:23], v[140:143]
    v_fmac_f32 v207, v43, v26
    v_mfma_f32_16x16x32_bf16 v[128:131], v[80:83], a[24:27], v[128:131]
    ds_read_b64_tr_b16 a[4:5], v33 offset:32768
    ds_read_b64_tr_b16 a[6:7], v33 offset:33792
    v_mfma_f32_16x16x32_bf16 v[136:139], v[84:87], a[24:27], v[136:139]
    v_permlane16_swap_b32 v192, v196
    v_permlane16_swap_b32 v193, v197
    s_waitcnt lgkmcnt(4)
    v_mfma_f32_16x16x32_bf16 v[132:135], v[80:83], a[28:31], v[132:135]
    ds_read_b64_tr_b16 a[8:9], v32 offset:40960
    ds_read_b64_tr_b16 a[10:11], v32 offset:41984
    v_mfma_f32_16x16x32_bf16 v[140:143], v[84:87], a[28:31], v[140:143]
    v_permlane16_swap_b32 v194, v198
    v_mfma_f32_16x16x32_bf16 v[128:131], v[64:67], a[32:35], v[128:131]
    ds_read_b64_tr_b16 a[12:13], v33 offset:40960
    ds_read_b64_tr_b16 a[14:15], v33 offset:41984
    v_mfma_f32_16x16x32_bf16 v[136:139], v[68:71], a[32:35], v[136:139]
    buffer_load_dwordx4 v[176:179], v28, s[60:63], s34 offen offset:0 sc1
    buffer_load_dwordx4 v[180:183], v28, s[60:63], s34 offen offset:1024 sc1
    buffer_load_dword v184, v8, s[60:63], s34 offen offset:2048 sc1
    v_mfma_f32_16x16x32_bf16 v[132:135], v[64:67], a[36:39], v[132:135]
    v_mfma_f32_16x16x32_bf16 v[140:143], v[68:71], a[36:39], v[140:143]
    v_permlane16_swap_b32 v195, v199
    v_permlane16_swap_b32 v200, v204
    v_mfma_f32_16x16x32_bf16 v[128:131], v[72:75], a[40:43], v[128:131]
    v_permlane16_swap_b32 v201, v205
    v_mfma_f32_16x16x32_bf16 v[136:139], v[76:79], a[40:43], v[136:139]
    v_permlane16_swap_b32 v202, v206
    v_permlane16_swap_b32 v203, v207
    v_mfma_f32_16x16x32_bf16 v[132:135], v[72:75], a[44:47], v[132:135]
    v_mfma_f32_16x16x32_bf16 v[140:143], v[76:79], a[44:47], v[140:143]
    s_waitcnt lgkmcnt(0)
    v_mfma_f32_16x16x32_bf16 v[128:131], v[48:51], a[0:3], v[128:131]
    v_mfma_f32_16x16x32_bf16 v[136:139], v[52:55], a[0:3], v[136:139]
    v_mfma_f32_16x16x32_bf16 v[132:135], v[48:51], a[4:7], v[132:135]
    v_mfma_f32_16x16x32_bf16 v[140:143], v[52:55], a[4:7], v[140:143]
    v_mfma_f32_16x16x32_bf16 v[128:131], v[56:59], a[8:11], v[128:131]
    v_mfma_f32_16x16x32_bf16 v[136:139], v[60:63], a[8:11], v[136:139]
    v_mfma_f32_16x16x32_bf16 v[132:135], v[56:59], a[12:15], v[132:135]
    v_mfma_f32_16x16x32_bf16 v[140:143], v[60:63], a[12:15], v[140:143]
    s_nop 4
    v_pk_add_f32 v[128:129], v[128:129], v[192:193]
    v_pk_add_f32 v[130:131], v[130:131], v[194:195]
    v_pk_add_f32 v[132:133], v[132:133], v[196:197]
    v_pk_add_f32 v[134:135], v[134:135], v[198:199]
    v_pk_add_f32 v[136:137], v[136:137], v[200:201]
    v_pk_add_f32 v[138:139], v[138:139], v[202:203]
    v_pk_add_f32 v[140:141], v[140:141], v[204:205]
    v_pk_add_f32 v[142:143], v[142:143], v[206:207]
    s_waitcnt vmcnt(9)
    v_bitop3_b32 v153, v144, v145, v152 bitop3:0x96
    v_bitop3_b32 v153, v146, v147, v153 bitop3:0x96
    v_bitop3_b32 v153, v148, v149, v153 bitop3:0x96
    v_bitop3_b32 v153, v150, v151, v153 bitop3:0x96
    v_cmp_ne_u32 vcc, s76, v153
    s_cbranch_vccnz L_retry_rx1
L_back_rx1:
    v_dot2c_f32_bf16 v128, s78, v144
    v_dot2c_f32_bf16 v129, s79, v144
    v_dot2c_f32_bf16 v130, s78, v145
    v_dot2c_f32_bf16 v131, s79, v145
    v_dot2c_f32_bf16 v132, s78, v146
    v_dot2c_f32_bf16 v133, s79, v146
    v_dot2c_f32_bf16 v134, s78, v147
    v_dot2c_f32_bf16 v135, s79, v147
    v_dot2c_f32_bf16 v136, s78, v148
    v_dot2c_f32_bf16 v137, s79, v148
    v_dot2c_f32_bf16 v138, s78, v149
    v_dot2c_f32_bf16 v139, s79, v149
    v_dot2c_f32_bf16 v140, s78, v150
    v_dot2c_f32_bf16 v141, s79, v150
    v_dot2c_f32_bf16 v142, s78, v151
    v_dot2c_f32_bf16 v143, s79, v151
    s_waitcnt vmcnt(6)
    v_bitop3_b32 v169, v160, v161, v168 bitop3:0x96
    v_bitop3_b32 v169, v162, v163, v169 bitop3:0x96
    v_bitop3_b32 v169, v164, v165, v169 bitop3:0x96
    v_bitop3_b32 v169, v166, v167, v169 bitop3:0x96
    v_cmp_ne_u32 vcc, s76, v169
    s_cbranch_vccnz L_retry_rx2
L_back_rx2:
    v_dot2c_f32_bf16 v128, s78, v160
    v_dot2c_f32_bf16 v129, s79, v160
    v_dot2c_f32_bf16 v130, s78, v161
    v_dot2c_f32_bf16 v131, s79, v161
    v_dot2c_f32_bf16 v132, s78, v162
    v_dot2c_f32_bf16 v133, s79, v162
    v_dot2c_f32_bf16 v134, s78, v163
    v_dot2c_f32_bf16 v135, s79, v163
    v_dot2c_f32_bf16 v136, s78, v164
    v_dot2c_f32_bf16 v137, s79, v164
    v_dot2c_f32_bf16 v138, s78, v165
    v_dot2c_f32_bf16 v139, s79, v165
    v_dot2c_f32_bf16 v140, s78, v166
    v_dot2c_f32_bf16 v141, s79, v166
    v_dot2c_f32_bf16 v142, s78, v167
    v_dot2c_f32_bf16 v143, s79, v167
    s_waitcnt vmcnt(0)
    v_bitop3_b32 v185, v176, v177, v184 bitop3:0x96
    v_bitop3_b32 v185, v178, v179, v185 bitop3:0x96
    v_bitop3_b32 v185, v180, v181, v185 bitop3:0x96
    v_bitop3_b32 v185, v182, v183, v185 bitop3:0x96
    v_cmp_ne_u32 vcc, s76, v185
    s_cbranch_vccnz L_retry_rx3
L_back_rx3:
    v_dot2c_f32_bf16 v128, s78, v176
    v_dot2c_f32_bf16 v129, s79, v176
    v_dot2c_f32_bf16 v130, s78, v177
    v_dot2c_f32_bf16 v131, s79, v177
    v_dot2c_f32_bf16 v132, s78, v178
    v_dot2c_f32_bf16 v133, s79, v178
    v_dot2c_f32_bf16 v134, s78, v179
    v_dot2c_f32_bf16 v135, s79, v179
    v_permlane16_swap_b32 v128, v132
    v_permlane16_swap_b32 v129, v133
    v_permlane16_swap_b32 v130, v134
    v_permlane16_swap_b32 v131, v135
    v_dot2c_f32_bf16 v136, s78, v180
    v_dot2c_f32_bf16 v137, s79, v180
    s_add_u32 s86, s85, 0
    buffer_store_dword v128, v24, s[64:67], s86 offen offset:0 nt
    buffer_store_dword v129, v24, s[64:67], s86 offen offset:2048 nt
    v_dot2c_f32_bf16 v138, s78, v181
    v_dot2c_f32_bf16 v139, s79, v181
    s_add_u32 s86, s85, 4096
    buffer_store_dword v130, v24, s[64:67], s86 offen offset:0 nt
    buffer_store_dword v131, v24, s[64:67], s86 offen offset:2048 nt
    v_dot2c_f32_bf16 v140, s78, v182
    v_dot2c_f32_bf16 v141, s79, v182
    s_add_u32 s86, s85, 32768
    buffer_store_dword v132, v24, s[64:67], s86 offen offset:0 nt
    buffer_store_dword v133, v24, s[64:67], s86 offen offset:2048 nt
    v_dot2c_f32_bf16 v142, s78, v183
    v_dot2c_f32_bf16 v143, s79, v183
    s_add_u32 s86, s85, 36864
    buffer_store_dword v134, v24, s[64:67], s86 offen offset:0 nt
    buffer_store_dword v135, v24, s[64:67], s86 offen offset:2048 nt
    v_permlane16_swap_b32 v136, v140
    v_permlane16_swap_b32 v137, v141
    v_permlane16_swap_b32 v138, v142
    v_permlane16_swap_b32 v139, v143
    s_lshl_b32 s101, s73, 2
    s_add_u32 s101, s101, s74
    s_xor_b32 s84, s72, 15
    s_or_b32 s101, s101, s84
    s_cmp_eq_u32 s101, 0
    s_cselect_b32 s101, 0, 0x7ff00000
    v_mov_b32 v1, s77
    v_mov_b32 v2, s101
    s_add_u32 s86, s85, 16384
    buffer_store_dword v136, v24, s[64:67], s86 offen offset:0 nt
    buffer_store_dword v137, v24, s[64:67], s86 offen offset:2048 nt
    s_add_u32 s86, s85, 20480
    buffer_store_dword v138, v24, s[64:67], s86 offen offset:0 nt
    buffer_store_dword v139, v24, s[64:67], s86 offen offset:2048 nt
    s_add_u32 s86, s85, 49152
    buffer_store_dword v140, v24, s[64:67], s86 offen offset:0 nt
    buffer_store_dword v141, v24, s[64:67], s86 offen offset:2048 nt
    s_add_u32 s86, s85, 53248
    buffer_store_dword v142, v24, s[64:67], s86 offen offset:0 nt
    buffer_store_dword v143, v24, s[64:67], s86 offen offset:2048 nt
    buffer_store_dword v1, v2, s[60:63], 0 offen
L_end:
    s_endpgm
L_retry_lb:
    s_mov_b32 s3, 20000
L_spin_lb:
    buffer_load_dwordx4 v[8:11], v35, s[60:63], 0 offen sc1
    buffer_load_dwordx4 v[20:23], v36, s[60:63], 0 offen sc1
    s_waitcnt vmcnt(0)
    v_bitop3_b32 v1, v9, v11, v37 bitop3:0x7e
    v_bitop3_b32 v2, v21, v23, v38 bitop3:0x7e
    v_or_b32 v1, v1, v2
    v_cmp_ne_u32 vcc, 0, v1
    s_cbranch_vccz L_back_lb
    s_sub_u32 s3, s3, 1
    s_cmp_lg_u32 s3, 0
    s_cbranch_scc1 L_spin_lb
    s_branch L_back_lb
L_retry_fa:
    s_mov_b32 s3, 20000
L_spin_fa:
    buffer_load_dword v31, v30, s[60:63], 0 offen offset:0 sc1
    s_waitcnt vmcnt(0)
    v_cmp_ne_u32 vcc, s76, v31
    s_cbranch_vccz L_back_fa
    s_sub_u32 s3, s3, 1
    s_cmp_lg_u32 s3, 0
    s_cbranch_scc1 L_spin_fa
    s_branch L_back_fa
L_retry_fh:
    s_mov_b32 s3, 20000
L_spin_fh:
    buffer_load_dword v31, v30, s[60:63], 0 offen offset:128 sc1
    s_waitcnt vmcnt(0)
    v_cmp_ne_u32 vcc, s76, v31
    s_cbranch_vccz L_back_fh
    s_sub_u32 s3, s3, 1
    s_cmp_lg_u32 s3, 0
    s_cbranch_scc1 L_spin_fh
    s_branch L_back_fh
L_retry_fl:
    s_mov_b32 s3, 20000
L_spin_fl:
    buffer_load_dword v31, v30, s[60:63], 0 offen offset:256 sc1
    s_waitcnt vmcnt(0)
    v_cmp_ne_u32 vcc, s76, v31
    s_cbranch_vccz L_back_fl
    s_sub_u32 s3, s3, 1
    s_cmp_lg_u32 s3, 0
    s_cbranch_scc1 L_spin_fl
    s_branch L_back_fl
L_retry_rx1:
    s_mov_b32 s3, 20000
L_spin_rx1:
    buffer_load_dwordx4 v[144:147], v28, s[60:63], s27 offen offset:0 sc1
    buffer_load_dwordx4 v[148:151], v28, s[60:63], s27 offen offset:1024 sc1
    buffer_load_dword v152, v8, s[60:63], s27 offen offset:2048 sc1
    buffer_load_dwordx4 v[160:163], v28, s[60:63], s33 offen offset:0 sc1
    buffer_load_dwordx4 v[164:167], v28, s[60:63], s33 offen offset:1024 sc1
    buffer_load_dword v168, v8, s[60:63], s33 offen offset:2048 sc1
    buffer_load_dwordx4 v[176:179], v28, s[60:63], s34 offen offset:0 sc1
    buffer_load_dwordx4 v[180:183], v28, s[60:63], s34 offen offset:1024 sc1
    buffer_load_dword v184, v8, s[60:63], s34 offen offset:2048 sc1
    s_waitcnt vmcnt(0)
    v_bitop3_b32 v153, v144, v145, v152 bitop3:0x96
    v_bitop3_b32 v153, v146, v147, v153 bitop3:0x96
    v_bitop3_b32 v153, v148, v149, v153 bitop3:0x96
    v_bitop3_b32 v153, v150, v151, v153 bitop3:0x96
    v_cmp_ne_u32 vcc, s76, v153
    s_cbranch_vccz L_back_rx1
    s_sub_u32 s3, s3, 1
    s_cmp_lg_u32 s3, 0
    s_cbranch_scc1 L_spin_rx1
    s_branch L_back_rx1
L_retry_rx2:
    s_mov_b32 s3, 20000
L_spin_rx2:
    buffer_load_dwordx4 v[160:163], v28, s[60:63], s33 offen offset:0 sc1
    buffer_load_dwordx4 v[164:167], v28, s[60:63], s33 offen offset:1024 sc1
    buffer_load_dword v168, v8, s[60:63], s33 offen offset:2048 sc1
    buffer_load_dwordx4 v[176:179], v28, s[60:63], s34 offen offset:0 sc1
    buffer_load_dwordx4 v[180:183], v28, s[60:63], s34 offen offset:1024 sc1
    buffer_load_dword v184, v8, s[60:63], s34 offen offset:2048 sc1
    s_waitcnt vmcnt(0)
    v_bitop3_b32 v169, v160, v161, v168 bitop3:0x96
    v_bitop3_b32 v169, v162, v163, v169 bitop3:0x96
    v_bitop3_b32 v169, v164, v165, v169 bitop3:0x96
    v_bitop3_b32 v169, v166, v167, v169 bitop3:0x96
    v_cmp_ne_u32 vcc, s76, v169
    s_cbranch_vccz L_back_rx2
    s_sub_u32 s3, s3, 1
    s_cmp_lg_u32 s3, 0
    s_cbranch_scc1 L_spin_rx2
    s_branch L_back_rx2
L_retry_rx3:
    s_mov_b32 s3, 20000
L_spin_rx3:
    buffer_load_dwordx4 v[176:179], v28, s[60:63], s34 offen offset:0 sc1
    buffer_load_dwordx4 v[180:183], v28, s[60:63], s34 offen offset:1024 sc1
    buffer_load_dword v184, v8, s[60:63], s34 offen offset:2048 sc1
    s_waitcnt vmcnt(0)
    v_bitop3_b32 v185, v176, v177, v184 bitop3:0x96
    v_bitop3_b32 v185, v178, v179, v185 bitop3:0x96
    v_bitop3_b32 v185, v180, v181, v185 bitop3:0x96
    v_bitop3_b32 v185, v182, v183, v185 bitop3:0x96
    v_cmp_ne_u32 vcc, s76, v185
    s_cbranch_vccz L_back_rx3
    s_sub_u32 s3, s3, 1
    s_cmp_lg_u32 s3, 0
    s_cbranch_scc1 L_spin_rx3
    s_branch L_back_rx3
L_code_end:
    s_endpgm
.section .rodata,"a"
.p2align 6
.amdhsa_kernel parallel_sum__ssm_conv_s5__dense_activation_mish__prompt_kernel
  .amdhsa_next_free_vgpr 512
  .amdhsa_next_free_sgpr 102
  .amdhsa_accum_offset 256
  .amdhsa_group_segment_fixed_size 0
  .amdhsa_kernarg_size 128
  .amdhsa_user_sgpr_count 2
  .amdhsa_user_sgpr_kernarg_segment_ptr 1
  .amdhsa_system_sgpr_workgroup_id_x 1
.end_amdhsa_kernel
```
